```python
import torch

def _softmax(x, axis=-1):
    return torch.softmax(x, dim=axis)
def _gelu(x):
    return torch.nn.functional.gelu(x, approximate="tanh")
def _silu(x):
    return torch.nn.functional.silu(x)
def _sigmoid(x):
    return torch.sigmoid(x)
def _layernorm(x, axis=-1, eps=1e-5):
    m = x.mean(dim=axis, keepdim=True)
    v = x.var(dim=axis, keepdim=True, unbiased=False)
    return (x - m) / torch.sqrt(v + eps)
def _scatter_add(tgt, idx, src, axis=0):
    return tgt.clone().index_add_(axis, idx, src)
def _segment_sum(src, seg, n):
    out = torch.zeros((n,) + src.shape[1:], dtype=src.dtype)
    return out.index_add_(0, seg, src)
def _pad(x, pw):
    flat = tuple(v for pair in reversed(pw) for v in pair)
    return torch.nn.functional.pad(x, flat)

kernel_name = 'parallel_sum__ssm_conv_h3__dense_activation_mish__prompt'

def setup_inputs():

    _w = (lambda a: (lambda t: t.to(torch.bfloat16) if t.is_floating_point() else t)(torch.as_tensor(a)))
    def _A_setup():
        B, S, D = 1, 2048, 448
        ks = 4
        return {
            "q": _w((lambda *s: torch.randn(*s, dtype=torch.bfloat16) * 0.05)(B, S, D)),
            "k": _w((lambda *s: torch.randn(*s, dtype=torch.bfloat16) * 0.2)(B, S, D)),
            "v": _w((lambda *s: torch.randn(*s, dtype=torch.bfloat16) * 0.2)(B, S, D)),
            "shift_k": _w((lambda *s: torch.randn(*s, dtype=torch.bfloat16) * 0.2)(D, ks) * 0.5),
            "ssm_k": _w((lambda *s: torch.randn(*s, dtype=torch.bfloat16) * 0.8)(D, S) * (1.0 / S ** 0.5)),
            "ssm_D": _w((lambda *s: torch.randn(*s, dtype=torch.bfloat16) * 0.2)(D)),
        }
    _A_in = _A_setup()

    def _B_setup():
        B, S, D, F = 1, 2048, 448, 1792
        return {
            "x": _w((lambda *s: torch.randn(*s, dtype=torch.bfloat16) * 0.05)(B, S, D)),
            "w1": _w((lambda *s: torch.randn(*s, dtype=torch.bfloat16) * 0.8)(D, F) * (D ** -0.5)),
            "b1": _w((lambda *s: torch.randn(*s, dtype=torch.bfloat16) * 0.2)(F)),
            "w2": _w((lambda *s: torch.randn(*s, dtype=torch.bfloat16) * 0.1)(F, D) * (F ** -0.5)),
        }
    _B_in = _B_setup()

    return {
        "A_q": _A_in["q"],
        "A_k": _A_in["k"],
        "A_v": _A_in["v"],
        "A_shift_k": _A_in["shift_k"],
        "A_ssm_k": _A_in["ssm_k"],
        "A_ssm_D": _A_in["ssm_D"],
        "B_x": _B_in["x"],
        "B_w1": _B_in["w1"],
        "B_b1": _B_in["b1"],
        "B_w2": _B_in["w2"],
    }

def reference(A_q, A_k, A_v, A_shift_k, A_ssm_k, A_ssm_D, B_x, B_w1, B_b1, B_w2):
    def _A_ref(q, k, v, shift_k, ssm_k, ssm_D):
        B, S, D = q.shape
        ks = shift_k.shape[-1]
        k_pad = _pad(k, ((0, 0), (ks - 1, 0), (0, 0)))
        k_shift = torch.zeros_like(k)
        for t in range(ks):
            k_shift = k_shift + k_pad[:, t:t + S, :] * shift_k[:, ks - 1 - t][None, None, :]
        kv = k_shift * v
        L = 2 * S
        kv_pad = _pad(kv, ((0, 0), (0, S), (0, 0)))
        kf_pad = _pad(ssm_k, ((0, 0), (0, S)))
        kv_f = (lambda x, axes=(-2,-1): torch.fft.rfft2(x.float(), dim=axes))(kv_pad[:, None, :, :], axes=(1, 2))
        kf_f = (lambda x, axes=(-2,-1): torch.fft.rfft2(x.float(), dim=axes))(kf_pad[:, None, :], axes=(1, 2))
        kf_f = (lambda x, *d: x.permute(*d))(kf_f, 1, 2, 0)
        y_f = kv_f * kf_f[None, :, :, :]
        y = (lambda x, s, axes=(-2,-1): torch.fft.irfft2(x, s=s, dim=axes).to(torch.bfloat16))(y_f, (1, L), axes=(1, 2))[:, 0, :S, :]
        y = y + kv * ssm_D[None, None, :]
        return q * y

    def _B_ref(x, w1, b1, w2):
        h = torch.einsum("bsd,df->bsf", x, w1) + b1
        sp = torch.log1p(torch.exp(-torch.abs(h))) + torch.where(h > 0, h, torch.zeros_like(h))
        act = h * torch.tanh(sp)
        return torch.einsum("bsf,fd->bsd", act, w2)

    x = A_q
    xn = _layernorm(x, axis=-1)
    return x + _A_ref(xn, A_k, A_v, A_shift_k, A_ssm_k, A_ssm_D) + _B_ref(xn, B_w1, B_b1, B_w2)
```

```asm
; @launch grid=(256,1,1) block=(256,1,1) lds=163840
.amdgcn_target "amdgcn-amd-amdhsa--gfx950"
.text
.globl parallel_sum__ssm_conv_h3__dense_activation_mish__prompt_kernel
.p2align 8
.type parallel_sum__ssm_conv_h3__dense_activation_mish__prompt_kernel,@function
parallel_sum__ssm_conv_h3__dense_activation_mish__prompt_kernel:
L_code_begin:
s_cmp_ge_u32 s2, 256
s_cbranch_scc1 L_end
s_load_dwordx16 s[4:19], s[0:1], 0
s_load_dwordx8 s[20:27], s[0:1], 64
s_load_dwordx2 s[28:29], s[0:1], 96
v_lshrrev_b32 v255, 6, v0
v_and_b32 v1, 63, v0
v_readfirstlane_b32 s73, v255
s_cmp_lt_u32 s2, 32
s_cbranch_scc1 L_help
s_sub_u32 s68, s2, 32
s_and_b32 s69, s68, 7
s_lshr_b32 s70, s68, 3
s_mul_i32 s71, s70, 37
s_lshr_b32 s71, s71, 8
s_mul_i32 s78, s71, 7
s_sub_u32 s72, s70, s78
v_lshrrev_b32 v251, 3, v1
v_and_b32 v250, 7, v1
v_lshrrev_b32 v249, 4, v1
v_and_b32 v248, 15, v1
v_mul_u32_u24 v247, 896, v251
s_lshr_b32 s78, s69, 1
s_lshl_b32 s75, s78, 2
s_add_u32 s75, s75, s71
s_and_b32 s79, s69, 1
s_mul_i32 s79, s79, 7
s_add_u32 s76, s79, s72
s_lshr_b32 s79, s72, 1
s_lshl_b32 s81, s79, 1
s_lshr_b32 s79, s71, 1
s_mul_i32 s79, s79, 3
s_add_u32 s81, s81, s79
s_add_u32 s79, s81, s78
s_mul_i32 s80, s79, 37
s_lshr_b32 s80, s80, 8
s_mul_i32 s80, s80, 7
s_sub_u32 s79, s79, s80
s_lshl_b32 s93, s79, 7
s_mul_i32 s94, s93, 1792
s_lshl_b32 s79, s75, 2
s_add_u32 s79, s79, s73
s_mul_i32 s79, s79, 28672
v_add_u32 v255, s79, v247
v_xor_b32 v254, v250, v249
v_lshl_add_u32 v242, v254, 4, v255
v_xor_b32 v254, 4, v254
v_lshl_add_u32 v243, v254, 4, v255
v_add_u32 v243, 7168, v243
v_add_u32 v244, 14336, v242
v_add_u32 v245, 14336, v243
s_mul_i32 s79, s73, 57344
s_lshl_b32 s80, s76, 8
s_add_u32 s79, s79, s80
v_mul_u32_u24 v255, 3584, v249
v_add_u32 v255, s79, v255
v_lshlrev_b32 v254, 2, v249
v_xor_b32 v254, v254, v248
v_lshl_add_u32 v246, v254, 4, v255
s_lshl_b32 s84, s73, 12
s_waitcnt lgkmcnt(0)
s_mov_b32 s48, s18
s_mov_b32 s49, s19
s_mov_b32 s50, 0x188000
s_mov_b32 s51, 0x00020000
s_mov_b32 s32, s4
s_mov_b32 s33, s5
s_mov_b32 s34, 0x1c0000
s_mov_b32 s35, 0x00020000
s_add_u32 m0, s84, 0x4000
s_add_u32 s95, s94, 0
buffer_load_dwordx4 v246, s[48:51], s95 offen lds
s_add_u32 m0, s84, 0x0
s_nop 0
buffer_load_dwordx4 v242, s[32:35], s93 offen lds
s_add_u32 m0, s84, 0x4400
s_add_u32 s95, s94, 14336
buffer_load_dwordx4 v246, s[48:51], s95 offen lds
s_add_u32 m0, s84, 0x400
s_nop 0
buffer_load_dwordx4 v243, s[32:35], s93 offen lds
s_lshl_b32 s74, s69, 2
s_add_u32 s74, s74, s71
s_add_u32 s99, s72, s69
s_mul_i32 s80, s99, 37
s_lshr_b32 s80, s80, 8
s_mul_i32 s80, s80, 7
s_sub_u32 s99, s99, s80
s_mov_b32 s36, s6
s_mov_b32 s37, s7
s_mov_b32 s38, 0x1c0000
s_mov_b32 s39, 0x00020000
s_mov_b32 s40, s8
s_mov_b32 s41, s9
s_mov_b32 s42, 0x1c0000
s_mov_b32 s43, 0x00020000
s_mov_b32 s44, s12
s_mov_b32 s45, s13
s_mov_b32 s46, 0x1c0000
s_mov_b32 s47, 0x00020000
s_mov_b32 s52, s22
s_mov_b32 s53, s23
s_mov_b32 s54, 0x188000
s_mov_b32 s55, 0x00020000
v_lshrrev_b32 v239, 5, v1
v_and_b32 v238, 31, v1
v_lshlrev_b32 v237, 4, v1
s_lshl_b32 s78, s74, 2
s_add_u32 s78, s78, s73
s_lshl_b32 s78, s78, 4
s_sub_u32 s78, s78, 4
s_mul_i32 s78, s78, 896
s_lshl_b32 s79, s72, 7
s_add_u32 s78, s78, s79
v_lshl_add_u32 v255, v250, 4, v247
v_add_u32 v232, s78, v255
v_add_u32 v233, 7168, v232
v_add_u32 v234, 14336, v232
v_add_u32 v235, 3584, v232
s_mul_i32 s85, s73, 5120
s_add_u32 s85, s85, 131584
s_lshl_b32 s79, s72, 9
v_lshlrev_b32 v236, 4, v238
v_add_u32 v236, s79, v236
s_lshl_b32 s79, s76, 8
v_and_b32 v226, 127, v0
v_lshlrev_b32 v226, 1, v226
v_add_u32 v226, s79, v226
s_lshr_b32 s86, s73, 1
s_and_b32 s87, s73, 1
s_mov_b32 s88, s86
s_mov_b32 s89, s87
s_lshl_b32 s78, s87, 13
v_lshlrev_b32 v255, 7, v238
v_add_u32 v255, s78, v255
v_bfe_u32 v254, v1, 1, 3
v_add_u32 v253, 0, v239
v_xor_b32 v253, v253, v254
v_lshl_add_u32 v2, v253, 4, v255
v_add_u32 v6, 0x10000, v2
v_add_u32 v253, 2, v239
v_xor_b32 v253, v253, v254
v_lshl_add_u32 v3, v253, 4, v255
v_add_u32 v7, 0x10000, v3
v_add_u32 v253, 4, v239
v_xor_b32 v253, v253, v254
v_lshl_add_u32 v4, v253, 4, v255
v_add_u32 v8, 0x10000, v4
v_add_u32 v253, 6, v239
v_xor_b32 v253, v253, v254
v_lshl_add_u32 v5, v253, 4, v255
v_add_u32 v9, 0x10000, v5
v_bfe_u32 v221, v1, 2, 2
v_and_b32 v220, 3, v1
v_and_b32 v254, 1, v249
v_lshlrev_b32 v254, 1, v254
v_lshrrev_b32 v253, 1, v220
v_add_u32 v219, v254, v253
v_and_b32 v218, 1, v220
v_lshlrev_b32 v218, 3, v218
v_lshlrev_b32 v255, 3, v239
v_add_u32 v255, v255, v221
v_lshl_add_u32 v255, v255, 8, v218
v_add_u32 v255, 16384, v255
s_lshl_b32 s78, s86, 3
v_add_u32 v254, s78, v219
v_lshlrev_b32 v252, 2, v221
s_xor_b32 s79, s87, 0
s_lshl_b32 s79, s79, 2
v_add_u32 v253, s79, v254
v_xor_b32 v253, v253, v252
v_lshl_add_u32 v222, v253, 4, v255
v_add_u32 v224, 0x10000, v222
s_xor_b32 s79, s87, 1
s_lshl_b32 s79, s79, 2
v_add_u32 v253, s79, v254
v_xor_b32 v253, v253, v252
v_lshl_add_u32 v223, v253, 4, v255
v_add_u32 v225, 0x10000, v223
s_lshl_b32 s16, s68, 1
s_add_u32 s16, s16, s88
s_lshl_b32 s16, s16, 12
s_add_u32 m0, s84, 0x4800
s_add_u32 s95, s94, 28672
buffer_load_dwordx4 v246, s[48:51], s95 offen lds
s_add_u32 m0, s84, 0x800
s_nop 0
buffer_load_dwordx4 v244, s[32:35], s93 offen lds
s_add_u32 m0, s84, 0x4c00
s_add_u32 s95, s94, 43008
buffer_load_dwordx4 v246, s[48:51], s95 offen lds
s_add_u32 m0, s84, 0xc00
s_nop 0
buffer_load_dwordx4 v245, s[32:35], s93 offen lds
s_mov_b32 s60, s28
s_mov_b32 s61, s29
s_mov_b32 s62, 0xb01000
s_mov_b32 s63, 0x00020000
v_mov_b32 v240, 0
buffer_load_dword v241, v240, s[60:63], 0 offen sc1
s_sub_u32 s79, s70, 12
s_cmp_lt_u32 s70, 16
s_cselect_b32 s79, s70, s79
s_lshl_b32 s79, s79, 2
s_add_u32 s79, s79, s73
s_lshl_b32 s80, s69, 6
s_add_u32 s17, s79, s80
s_lshl_b32 s79, s17, 2
v_add_u32 v215, s79, v249
v_mul_u32_u24 v216, 896, v215
v_lshl_add_u32 v216, v248, 4, v216
v_add_u32 v217, 768, v216
v_cmp_gt_u32 vcc, 8, v248
v_mov_b32 v254, 0x7ffffff0
s_nop 0
v_cndmask_b32 v217, v254, v217, vcc
v_mov_b32 v208, 0x3f803f80
v_mov_b32 v209, 0x3f803f80
v_mov_b32 v210, 0x3f803f80
v_mov_b32 v211, 0x3f803f80
v_mov_b32 v28, 0
v_mov_b32 v29, 0
v_mov_b32 v30, 0
v_mov_b32 v31, 0
v_mov_b32 v32, 0
v_mov_b32 v33, 0
v_mov_b32 v34, 0
v_mov_b32 v35, 0
v_mov_b32 v36, 0
v_mov_b32 v37, 0
v_mov_b32 v38, 0
v_mov_b32 v39, 0
v_mov_b32 v40, 0
v_mov_b32 v41, 0
v_mov_b32 v42, 0
v_mov_b32 v43, 0
v_mov_b32 v44, 0
v_mov_b32 v45, 0
v_mov_b32 v46, 0
v_mov_b32 v47, 0
v_mov_b32 v48, 0
v_mov_b32 v49, 0
v_mov_b32 v50, 0
v_mov_b32 v51, 0
v_mov_b32 v52, 0
v_mov_b32 v53, 0
v_mov_b32 v54, 0
v_mov_b32 v55, 0
v_mov_b32 v56, 0
v_mov_b32 v57, 0
v_mov_b32 v58, 0
v_mov_b32 v59, 0
v_mov_b32 v60, 0
v_mov_b32 v61, 0
v_mov_b32 v62, 0
v_mov_b32 v63, 0
v_mov_b32 v64, 0
v_mov_b32 v65, 0
v_mov_b32 v66, 0
v_mov_b32 v67, 0
v_mov_b32 v68, 0
v_mov_b32 v69, 0
v_mov_b32 v70, 0
v_mov_b32 v71, 0
v_mov_b32 v72, 0
v_mov_b32 v73, 0
v_mov_b32 v74, 0
v_mov_b32 v75, 0
v_mov_b32 v76, 0
v_mov_b32 v77, 0
v_mov_b32 v78, 0
v_mov_b32 v79, 0
v_mov_b32 v80, 0
v_mov_b32 v81, 0
v_mov_b32 v82, 0
v_mov_b32 v83, 0
v_mov_b32 v84, 0
v_mov_b32 v85, 0
v_mov_b32 v86, 0
v_mov_b32 v87, 0
v_mov_b32 v88, 0
v_mov_b32 v89, 0
v_mov_b32 v90, 0
v_mov_b32 v91, 0
v_mov_b32 v92, 0
v_mov_b32 v93, 0
s_add_u32 s93, s93, 128
s_cmp_eq_u32 s93, 896
s_cselect_b32 s93, 0, s93
s_mul_i32 s94, s93, 1792
s_add_u32 m0, s84, 0xc000
s_add_u32 s95, s94, 0
buffer_load_dwordx4 v246, s[48:51], s95 offen lds
s_add_u32 m0, s84, 0x8000
s_nop 0
buffer_load_dwordx4 v242, s[32:35], s93 offen lds
s_add_u32 m0, s84, 0xc400
s_add_u32 s95, s94, 14336
buffer_load_dwordx4 v246, s[48:51], s95 offen lds
s_add_u32 m0, s84, 0x8400
s_nop 0
buffer_load_dwordx4 v243, s[32:35], s93 offen lds
s_add_u32 m0, s84, 0xc800
s_add_u32 s95, s94, 28672
buffer_load_dwordx4 v246, s[48:51], s95 offen lds
s_add_u32 m0, s84, 0x8800
s_nop 0
buffer_load_dwordx4 v244, s[32:35], s93 offen lds
s_add_u32 m0, s84, 0xcc00
s_add_u32 s95, s94, 43008
buffer_load_dwordx4 v246, s[48:51], s95 offen lds
s_add_u32 m0, s84, 0x8c00
s_nop 0
buffer_load_dwordx4 v245, s[32:35], s93 offen lds
s_waitcnt vmcnt(9)
s_barrier
ds_read_b64_tr_b16 v[108:109], v222 offset:0
ds_read_b64_tr_b16 v[110:111], v222 offset:1024
ds_read_b64_tr_b16 v[112:113], v223 offset:0
ds_read_b64_tr_b16 v[114:115], v223 offset:1024
ds_read_b128 v[116:119], v2 offset:0
ds_read_b128 v[120:123], v2 offset:4096
s_waitcnt lgkmcnt(0)
v_mfma_f32_32x32x16_bf16 v[28:43], v[108:111], v[116:119], v[28:43]
ds_read_b64_tr_b16 v[124:125], v222 offset:4096
ds_read_b64_tr_b16 v[126:127], v222 offset:5120
v_mfma_f32_32x32x16_bf16 v[44:59], v[108:111], v[120:123], v[44:59]
ds_read_b64_tr_b16 v[128:129], v223 offset:4096
ds_read_b64_tr_b16 v[130:131], v223 offset:5120
buffer_load_dwordx4 v[12:15], v216, s[32:35], 0 offen offset:0
v_mfma_f32_32x32x16_bf16 v[60:75], v[112:115], v[116:119], v[60:75]
ds_read_b128 v[132:135], v3 offset:0
ds_read_b128 v[136:139], v3 offset:4096
v_mfma_f32_32x32x16_bf16 v[76:91], v[112:115], v[120:123], v[76:91]
buffer_load_dwordx4 v[16:19], v216, s[32:35], 0 offen offset:256
v_dot2_f32_bf16 v92, v108, v208, v92
v_dot2_f32_bf16 v93, v109, v208, v93
v_dot2_f32_bf16 v92, v110, v208, v92
v_dot2_f32_bf16 v93, v111, v208, v93
buffer_load_dwordx4 v[20:23], v216, s[32:35], 0 offen offset:512
s_waitcnt lgkmcnt(0)
v_mfma_f32_32x32x16_bf16 v[28:43], v[124:127], v[132:135], v[28:43]
ds_read_b64_tr_b16 v[108:109], v222 offset:8192
ds_read_b64_tr_b16 v[110:111], v222 offset:9216
v_mfma_f32_32x32x16_bf16 v[44:59], v[124:127], v[136:139], v[44:59]
ds_read_b64_tr_b16 v[112:113], v223 offset:8192
ds_read_b64_tr_b16 v[114:115], v223 offset:9216
buffer_load_dwordx4 v[24:27], v217, s[32:35], 0 offen
v_mfma_f32_32x32x16_bf16 v[60:75], v[128:131], v[132:135], v[60:75]
ds_read_b128 v[116:119], v4 offset:0
ds_read_b128 v[120:123], v4 offset:4096
v_mfma_f32_32x32x16_bf16 v[76:91], v[128:131], v[136:139], v[76:91]
s_add_u32 s93, s93, 128
s_cmp_eq_u32 s93, 896
s_cselect_b32 s93, 0, s93
s_mul_i32 s94, s93, 1792
s_add_u32 m0, s84, 0x14000
s_add_u32 s95, s94, 0
buffer_load_dwordx4 v246, s[48:51], s95 offen lds
v_dot2_f32_bf16 v92, v124, v208, v92
v_dot2_f32_bf16 v93, v125, v208, v93
v_dot2_f32_bf16 v92, v126, v208, v92
v_dot2_f32_bf16 v93, v127, v208, v93
s_add_u32 m0, s84, 0x10000
s_nop 0
buffer_load_dwordx4 v242, s[32:35], s93 offen lds
s_waitcnt lgkmcnt(0)
v_mfma_f32_32x32x16_bf16 v[28:43], v[108:111], v[116:119], v[28:43]
ds_read_b64_tr_b16 v[124:125], v222 offset:12288
ds_read_b64_tr_b16 v[126:127], v222 offset:13312
v_mfma_f32_32x32x16_bf16 v[44:59], v[108:111], v[120:123], v[44:59]
ds_read_b64_tr_b16 v[128:129], v223 offset:12288
ds_read_b64_tr_b16 v[130:131], v223 offset:13312
s_add_u32 m0, s84, 0x14400
s_add_u32 s95, s94, 14336
buffer_load_dwordx4 v246, s[48:51], s95 offen lds
v_mfma_f32_32x32x16_bf16 v[60:75], v[112:115], v[116:119], v[60:75]
ds_read_b128 v[132:135], v5 offset:0
ds_read_b128 v[136:139], v5 offset:4096
v_mfma_f32_32x32x16_bf16 v[76:91], v[112:115], v[120:123], v[76:91]
s_add_u32 m0, s84, 0x10400
s_nop 0
buffer_load_dwordx4 v243, s[32:35], s93 offen lds
v_dot2_f32_bf16 v92, v108, v208, v92
v_dot2_f32_bf16 v93, v109, v208, v93
v_dot2_f32_bf16 v92, v110, v208, v92
v_dot2_f32_bf16 v93, v111, v208, v93
s_add_u32 m0, s84, 0x14800
s_add_u32 s95, s94, 28672
buffer_load_dwordx4 v246, s[48:51], s95 offen lds
s_waitcnt lgkmcnt(0)
s_waitcnt vmcnt(9)
s_barrier
s_add_u32 m0, s84, 0x10800
s_nop 0
buffer_load_dwordx4 v244, s[32:35], s93 offen lds
s_add_u32 m0, s84, 0x14c00
s_add_u32 s95, s94, 43008
buffer_load_dwordx4 v246, s[48:51], s95 offen lds
s_add_u32 m0, s84, 0x10c00
s_nop 0
buffer_load_dwordx4 v245, s[32:35], s93 offen lds
v_mfma_f32_32x32x16_bf16 v[28:43], v[124:127], v[132:135], v[28:43]
ds_read_b64_tr_b16 v[108:109], v222 offset:32768
ds_read_b64_tr_b16 v[110:111], v222 offset:33792
v_mfma_f32_32x32x16_bf16 v[44:59], v[124:127], v[136:139], v[44:59]
ds_read_b64_tr_b16 v[112:113], v223 offset:32768
ds_read_b64_tr_b16 v[114:115], v223 offset:33792
s_add_u32 s93, s93, 128
s_cmp_eq_u32 s93, 896
s_cselect_b32 s93, 0, s93
s_mul_i32 s94, s93, 1792
s_add_u32 m0, s84, 0x4000
s_add_u32 s95, s94, 0
buffer_load_dwordx4 v246, s[48:51], s95 offen lds
v_mfma_f32_32x32x16_bf16 v[60:75], v[128:131], v[132:135], v[60:75]
ds_read_b128 v[116:119], v2 offset:32768
ds_read_b128 v[120:123], v2 offset:36864
v_mfma_f32_32x32x16_bf16 v[76:91], v[128:131], v[136:139], v[76:91]
s_add_u32 m0, s84, 0x0
s_nop 0
buffer_load_dwordx4 v242, s[32:35], s93 offen lds
v_dot2_f32_bf16 v92, v124, v208, v92
v_dot2_f32_bf16 v93, v125, v208, v93
v_dot2_f32_bf16 v92, v126, v208, v92
v_dot2_f32_bf16 v93, v127, v208, v93
s_add_u32 m0, s84, 0x4400
s_add_u32 s95, s94, 14336
buffer_load_dwordx4 v246, s[48:51], s95 offen lds
s_waitcnt lgkmcnt(0)
v_mfma_f32_32x32x16_bf16 v[28:43], v[108:111], v[116:119], v[28:43]
ds_read_b64_tr_b16 v[124:125], v222 offset:36864
ds_read_b64_tr_b16 v[126:127], v222 offset:37888
v_mfma_f32_32x32x16_bf16 v[44:59], v[108:111], v[120:123], v[44:59]
ds_read_b64_tr_b16 v[128:129], v223 offset:36864
ds_read_b64_tr_b16 v[130:131], v223 offset:37888
s_add_u32 m0, s84, 0x400
s_nop 0
buffer_load_dwordx4 v243, s[32:35], s93 offen lds
v_mfma_f32_32x32x16_bf16 v[60:75], v[112:115], v[116:119], v[60:75]
ds_read_b128 v[132:135], v3 offset:32768
ds_read_b128 v[136:139], v3 offset:36864
v_mfma_f32_32x32x16_bf16 v[76:91], v[112:115], v[120:123], v[76:91]
s_add_u32 m0, s84, 0x4800
s_add_u32 s95, s94, 28672
buffer_load_dwordx4 v246, s[48:51], s95 offen lds
v_dot2_f32_bf16 v92, v108, v208, v92
v_dot2_f32_bf16 v93, v109, v208, v93
v_dot2_f32_bf16 v92, v110, v208, v92
v_dot2_f32_bf16 v93, v111, v208, v93
s_add_u32 m0, s84, 0x800
s_nop 0
buffer_load_dwordx4 v244, s[32:35], s93 offen lds
s_waitcnt vmcnt(14)
v_mov_b32 v204, 0
v_mov_b32 v205, 0
v_mov_b32 v206, 0
v_mov_b32 v207, 0
v_dot2_f32_bf16 v204, v12, v208, v204
v_dot2_f32_bf16 v206, v12, v12, v206
v_dot2_f32_bf16 v205, v13, v208, v205
v_dot2_f32_bf16 v207, v13, v13, v207
v_dot2_f32_bf16 v204, v14, v208, v204
v_dot2_f32_bf16 v206, v14, v14, v206
v_dot2_f32_bf16 v205, v15, v208, v205
v_dot2_f32_bf16 v207, v15, v15, v207
v_dot2_f32_bf16 v204, v16, v208, v204
v_dot2_f32_bf16 v206, v16, v16, v206
s_add_u32 m0, s84, 0x4c00
s_add_u32 s95, s94, 43008
buffer_load_dwordx4 v246, s[48:51], s95 offen lds
v_dot2_f32_bf16 v205, v17, v208, v205
v_dot2_f32_bf16 v207, v17, v17, v207
v_dot2_f32_bf16 v204, v18, v208, v204
v_dot2_f32_bf16 v206, v18, v18, v206
v_dot2_f32_bf16 v205, v19, v208, v205
v_dot2_f32_bf16 v207, v19, v19, v207
v_dot2_f32_bf16 v204, v20, v208, v204
v_dot2_f32_bf16 v206, v20, v20, v206
v_dot2_f32_bf16 v205, v21, v208, v205
v_dot2_f32_bf16 v207, v21, v21, v207
s_add_u32 m0, s84, 0xc00
s_nop 0
buffer_load_dwordx4 v245, s[32:35], s93 offen lds
v_dot2_f32_bf16 v204, v22, v208, v204
v_dot2_f32_bf16 v206, v22, v22, v206
v_dot2_f32_bf16 v205, v23, v208, v205
v_dot2_f32_bf16 v207, v23, v23, v207
v_dot2_f32_bf16 v204, v24, v208, v204
v_dot2_f32_bf16 v206, v24, v24, v206
v_dot2_f32_bf16 v205, v25, v208, v205
v_dot2_f32_bf16 v207, v25, v25, v207
v_dot2_f32_bf16 v204, v26, v208, v204
v_dot2_f32_bf16 v206, v26, v26, v206
v_dot2_f32_bf16 v205, v27, v208, v205
v_dot2_f32_bf16 v207, v27, v27, v207
s_nop 1
v_add_f32 v204, v204, v205
v_add_f32 v206, v206, v207
s_nop 0
v_add_f32_dpp v204, v204, v204 row_ror:8 row_mask:0xf bank_mask:0xf
v_add_f32_dpp v206, v206, v206 row_ror:8 row_mask:0xf bank_mask:0xf
s_nop 0
v_add_f32_dpp v204, v204, v204 row_ror:4 row_mask:0xf bank_mask:0xf
v_add_f32_dpp v206, v206, v206 row_ror:4 row_mask:0xf bank_mask:0xf
s_nop 0
v_add_f32_dpp v204, v204, v204 row_ror:2 row_mask:0xf bank_mask:0xf
v_add_f32_dpp v206, v206, v206 row_ror:2 row_mask:0xf bank_mask:0xf
s_nop 0
v_add_f32_dpp v204, v204, v204 row_ror:1 row_mask:0xf bank_mask:0xf
v_add_f32_dpp v206, v206, v206 row_ror:1 row_mask:0xf bank_mask:0xf
v_mul_f32 v200, 0x3b124925, v204
v_mul_f32 v206, 0x3b124925, v206
v_fma_f32 v206, -v200, v200, v206
v_max_f32 v206, 0, v206
v_add_f32 v206, 0x3727c5ac, v206
v_rsq_f32 v202, v206
s_mov_b32 s78, 0x41c64e6d
v_mul_lo_u32 v241, v241, s78
v_add_u32 v241, 0x3039, v241
s_nop 0
v_readfirstlane_b32 s77, v241
s_nop 1
v_mov_b32 v201, s77
v_mov_b32 v203, s77
v_lshlrev_b32 v255, 4, v215
v_add_u32 v255, 458752, v255
s_mov_b32 exec_lo, 0x00010001
s_mov_b32 exec_hi, 0x00010001
buffer_store_dwordx4 v[200:203], v255, s[60:63], 0 offen sc1
s_mov_b64 exec, -1
s_waitcnt lgkmcnt(0)
v_mfma_f32_32x32x16_bf16 v[28:43], v[124:127], v[132:135], v[28:43]
ds_read_b64_tr_b16 v[108:109], v222 offset:40960
ds_read_b64_tr_b16 v[110:111], v222 offset:41984
v_mfma_f32_32x32x16_bf16 v[44:59], v[124:127], v[136:139], v[44:59]
ds_read_b64_tr_b16 v[112:113], v223 offset:40960
ds_read_b64_tr_b16 v[114:115], v223 offset:41984
s_add_u32 m0, s85, 0x0
s_nop 0
buffer_load_dwordx4 v232, s[36:39], 0 offen lds
v_mfma_f32_32x32x16_bf16 v[60:75], v[128:131], v[132:135], v[60:75]
ds_read_b128 v[116:119], v4 offset:32768
ds_read_b128 v[120:123], v4 offset:36864
v_mfma_f32_32x32x16_bf16 v[76:91], v[128:131], v[136:139], v[76:91]
s_add_u32 m0, s85, 0x400
s_nop 0
buffer_load_dwordx4 v233, s[36:39], 0 offen lds
v_dot2_f32_bf16 v92, v124, v208, v92
v_dot2_f32_bf16 v93, v125, v208, v93
v_dot2_f32_bf16 v92, v126, v208, v92
v_dot2_f32_bf16 v93, v127, v208, v93
s_add_u32 m0, s85, 0x800
s_nop 0
buffer_load_dwordx4 v234, s[36:39], 0 offen lds
s_waitcnt lgkmcnt(0)
v_mfma_f32_32x32x16_bf16 v[28:43], v[108:111], v[116:119], v[28:43]
ds_read_b64_tr_b16 v[124:125], v222 offset:45056
ds_read_b64_tr_b16 v[126:127], v222 offset:46080
s_lshr_b32 s0, s68, 3
s_lshl_b32 s0, s0, 7
v_mfma_f32_32x32x16_bf16 v[44:59], v[108:111], v[120:123], v[44:59]
ds_read_b64_tr_b16 v[128:129], v223 offset:45056
ds_read_b64_tr_b16 v[130:131], v223 offset:46080
s_add_u32 m0, s85, 0xc00
s_nop 0
buffer_load_dwordx4 v235, s[40:43], 0 offen lds
s_add_u32 s0, s0, 8192
v_mfma_f32_32x32x16_bf16 v[60:75], v[112:115], v[116:119], v[60:75]
ds_read_b128 v[132:135], v5 offset:32768
ds_read_b128 v[136:139], v5 offset:36864
v_lshlrev_b32 v201, 2, v238
v_add_u32 v196, s0, v201
v_mfma_f32_32x32x16_bf16 v[76:91], v[112:115], v[120:123], v[76:91]
s_add_u32 m0, s85, 0x1000
s_movk_i32 s95, 7168
buffer_load_dwordx4 v235, s[40:43], s95 offen lds
s_mul_i32 s91, s73, 22528
v_dot2_f32_bf16 v92, v108, v208, v92
v_dot2_f32_bf16 v93, v109, v208, v93
v_dot2_f32_bf16 v92, v110, v208, v92
v_dot2_f32_bf16 v93, v111, v208, v93
global_load_dwordx4 v[228:231], v236, s[10:11]
s_mul_i32 s1, s73, 401408
s_lshl_b32 s0, s72, 7
s_waitcnt lgkmcnt(0)
s_waitcnt vmcnt(15)
s_barrier
v_mfma_f32_32x32x16_bf16 v[28:43], v[124:127], v[132:135], v[28:43]
ds_read_b64_tr_b16 v[108:109], v224 offset:0
ds_read_b64_tr_b16 v[110:111], v224 offset:1024
s_add_u32 s1, s1, s0
v_add_u32 v216, s1, v247
v_mfma_f32_32x32x16_bf16 v[44:59], v[124:127], v[136:139], v[44:59]
ds_read_b64_tr_b16 v[112:113], v225 offset:0
ds_read_b64_tr_b16 v[114:115], v225 offset:1024
s_add_u32 s93, s93, 128
s_cmp_eq_u32 s93, 896
s_cselect_b32 s93, 0, s93
s_mul_i32 s94, s93, 1792
s_add_u32 m0, s84, 0xc000
s_add_u32 s95, s94, 0
buffer_load_dwordx4 v246, s[48:51], s95 offen lds
v_and_b32 v201, 1, v249
v_mfma_f32_32x32x16_bf16 v[60:75], v[128:131], v[132:135], v[60:75]
ds_read_b128 v[116:119], v6 offset:0
ds_read_b128 v[120:123], v6 offset:4096
v_lshlrev_b32 v201, 2, v201
v_xor_b32 v201, v201, v250
v_mfma_f32_32x32x16_bf16 v[76:91], v[128:131], v[136:139], v[76:91]
s_add_u32 m0, s84, 0x8000
s_nop 0
buffer_load_dwordx4 v242, s[32:35], s93 offen lds
v_lshl_add_u32 v216, v201, 4, v216
v_dot2_f32_bf16 v92, v124, v208, v92
v_dot2_f32_bf16 v93, v125, v208, v93
v_dot2_f32_bf16 v92, v126, v208, v92
v_dot2_f32_bf16 v93, v127, v208, v93
s_add_u32 m0, s84, 0xc400
s_add_u32 s95, s94, 14336
buffer_load_dwordx4 v246, s[48:51], s95 offen lds
v_add_u32 v217, 7168, v216
s_mul_i32 s92, s88, 9280
s_waitcnt lgkmcnt(0)
v_mfma_f32_32x32x16_bf16 v[28:43], v[108:111], v[116:119], v[28:43]
ds_read_b64_tr_b16 v[124:125], v224 offset:4096
ds_read_b64_tr_b16 v[126:127], v224 offset:5120
s_add_u32 s92, s92, 131584
s_mul_i32 s1, s88, 16640
v_mfma_f32_32x32x16_bf16 v[44:59], v[108:111], v[120:123], v[44:59]
ds_read_b64_tr_b16 v[128:129], v225 offset:4096
ds_read_b64_tr_b16 v[130:131], v225 offset:5120
s_add_u32 m0, s84, 0x8400
s_nop 0
buffer_load_dwordx4 v243, s[32:35], s93 offen lds
s_add_u32 s1, s1, 98304
v_mfma_f32_32x32x16_bf16 v[60:75], v[112:115], v[116:119], v[60:75]
ds_read_b128 v[132:135], v7 offset:0
ds_read_b128 v[136:139], v7 offset:4096
v_mul_u32_u24 v202, 4160, v249
v_lshl_add_u32 v202, v248, 2, v202
v_mfma_f32_32x32x16_bf16 v[76:91], v[112:115], v[120:123], v[76:91]
s_add_u32 m0, s84, 0xc800
s_add_u32 s95, s94, 28672
buffer_load_dwordx4 v246, s[48:51], s95 offen lds
v_add_u32 v202, s1, v202
v_dot2_f32_bf16 v92, v108, v208, v92
v_dot2_f32_bf16 v93, v109, v208, v93
v_dot2_f32_bf16 v92, v110, v208, v92
v_dot2_f32_bf16 v93, v111, v208, v93
s_add_u32 m0, s84, 0x8800
s_nop 0
buffer_load_dwordx4 v244, s[32:35], s93 offen lds
s_lshl_b32 s0, s89, 8
s_add_u32 s1, s1, s0
s_waitcnt lgkmcnt(0)
v_mfma_f32_32x32x16_bf16 v[28:43], v[124:127], v[132:135], v[28:43]
ds_read_b64_tr_b16 v[108:109], v224 offset:8192
ds_read_b64_tr_b16 v[110:111], v224 offset:9216
v_mul_u32_u24 v241, 4160, v220
v_add_u32 v201, v221, v249
v_mfma_f32_32x32x16_bf16 v[44:59], v[124:127], v[136:139], v[44:59]
ds_read_b64_tr_b16 v[112:113], v225 offset:8192
ds_read_b64_tr_b16 v[114:115], v225 offset:9216
s_add_u32 m0, s84, 0xcc00
s_add_u32 s95, s94, 43008
buffer_load_dwordx4 v246, s[48:51], s95 offen lds
v_lshl_add_u32 v241, v201, 4, v241
v_mfma_f32_32x32x16_bf16 v[60:75], v[128:131], v[132:135], v[60:75]
ds_read_b128 v[116:119], v8 offset:0
ds_read_b128 v[120:123], v8 offset:4096
v_add_u32 v241, s1, v241
v_and_b32 v212, 1, v1
v_mfma_f32_32x32x16_bf16 v[76:91], v[128:131], v[136:139], v[76:91]
s_add_u32 m0, s84, 0x8c00
s_nop 0
buffer_load_dwordx4 v245, s[32:35], s93 offen lds
v_bfe_u32 v199, v1, 1, 3
v_dot2_f32_bf16 v92, v124, v208, v92
v_dot2_f32_bf16 v93, v125, v208, v93
v_dot2_f32_bf16 v92, v126, v208, v92
v_dot2_f32_bf16 v93, v127, v208, v93
global_load_ushort v227, v226, s[20:21]
v_lshlrev_b32 v199, 6, v199
v_mul_u32_u24 v201, 4640, v212
s_waitcnt lgkmcnt(0)
v_mfma_f32_32x32x16_bf16 v[28:43], v[108:111], v[116:119], v[28:43]
ds_read_b64_tr_b16 v[124:125], v224 offset:12288
ds_read_b64_tr_b16 v[126:127], v224 offset:13312
v_sub_u32 v201, v201, v199
v_add_u32 v201, s92, v201
v_mfma_f32_32x32x16_bf16 v[44:59], v[108:111], v[120:123], v[44:59]
ds_read_b64_tr_b16 v[128:129], v225 offset:12288
ds_read_b64_tr_b16 v[130:131], v225 offset:13312
v_lshlrev_b32 v200, 4, v249
v_mfma_f32_32x32x16_bf16 v[60:75], v[112:115], v[116:119], v[60:75]
ds_read_b128 v[132:135], v9 offset:0
ds_read_b128 v[136:139], v9 offset:4096
v_add_u32 v215, v201, v200
s_add_u32 s0, s0, 448
v_mfma_f32_32x32x16_bf16 v[76:91], v[112:115], v[120:123], v[76:91]
v_add_u32 v215, s0, v215
v_dot2_f32_bf16 v92, v108, v208, v92
v_dot2_f32_bf16 v93, v109, v208, v93
v_dot2_f32_bf16 v92, v110, v208, v92
v_dot2_f32_bf16 v93, v111, v208, v93
v_sub_u32 v214, v201, v200
s_lshl_b32 s0, s89, 11
s_waitcnt lgkmcnt(0)
s_waitcnt vmcnt(16)
s_barrier
v_mfma_f32_32x32x16_bf16 v[28:43], v[124:127], v[132:135], v[28:43]
ds_read_b64_tr_b16 v[108:109], v222 offset:0
ds_read_b64_tr_b16 v[110:111], v222 offset:1024
s_sub_u32 s1, 2544, s0
v_add_u32 v214, s1, v214
v_mfma_f32_32x32x16_bf16 v[44:59], v[124:127], v[136:139], v[44:59]
ds_read_b64_tr_b16 v[112:113], v223 offset:0
ds_read_b64_tr_b16 v[114:115], v223 offset:1024
s_add_u32 s93, s93, 128
s_cmp_eq_u32 s93, 896
s_cselect_b32 s93, 0, s93
s_mul_i32 s94, s93, 1792
s_add_u32 m0, s84, 0x14000
s_add_u32 s95, s94, 0
buffer_load_dwordx4 v246, s[48:51], s95 offen lds
s_add_u32 s0, s0, s16
v_mfma_f32_32x32x16_bf16 v[60:75], v[128:131], v[132:135], v[60:75]
ds_read_b128 v[116:119], v2 offset:0
ds_read_b128 v[120:123], v2 offset:4096
s_add_u32 s0, s0, 2363392
v_add_u32 v213, v199, v200
v_mfma_f32_32x32x16_bf16 v[76:91], v[128:131], v[136:139], v[76:91]
s_add_u32 m0, s84, 0x10000
s_nop 0
buffer_load_dwordx4 v242, s[32:35], s93 offen lds
v_lshl_add_u32 v213, v212, 3, v213
v_dot2_f32_bf16 v92, v124, v208, v92
v_dot2_f32_bf16 v93, v125, v208, v93
v_dot2_f32_bf16 v92, v126, v208, v92
v_dot2_f32_bf16 v93, v127, v208, v93
s_add_u32 m0, s84, 0x14400
s_add_u32 s95, s94, 14336
buffer_load_dwordx4 v246, s[48:51], s95 offen lds
v_add_u32 v213, s0, v213
s_lshl_b32 s1, s89, 11
s_waitcnt lgkmcnt(0)
v_mfma_f32_32x32x16_bf16 v[28:43], v[108:111], v[116:119], v[28:43]
ds_read_b64_tr_b16 v[124:125], v222 offset:4096
ds_read_b64_tr_b16 v[126:127], v222 offset:5120
s_add_u32 s0, s1, s92
v_add_u32 v203, s0, v237
v_mfma_f32_32x32x16_bf16 v[44:59], v[108:111], v[120:123], v[44:59]
ds_read_b64_tr_b16 v[128:129], v223 offset:4096
ds_read_b64_tr_b16 v[130:131], v223 offset:5120
s_add_u32 m0, s84, 0x10400
s_nop 0
buffer_load_dwordx4 v243, s[32:35], s93 offen lds
s_add_u32 s1, s1, s16
v_mfma_f32_32x32x16_bf16 v[60:75], v[112:115], v[116:119], v[60:75]
ds_read_b128 v[132:135], v3 offset:0
ds_read_b128 v[136:139], v3 offset:4096
s_add_u32 s1, s1, 524288
v_add_u32 v195, s1, v237
v_mfma_f32_32x32x16_bf16 v[76:91], v[112:115], v[120:123], v[76:91]
s_add_u32 m0, s84, 0x14800
s_add_u32 s95, s94, 28672
buffer_load_dwordx4 v246, s[48:51], s95 offen lds
v_cmp_eq_u32 s[96:97], 1, v212
v_dot2_f32_bf16 v92, v108, v208, v92
v_dot2_f32_bf16 v93, v109, v208, v93
v_dot2_f32_bf16 v92, v110, v208, v92
v_dot2_f32_bf16 v93, v111, v208, v93
s_add_u32 m0, s84, 0x10800
s_nop 0
buffer_load_dwordx4 v244, s[32:35], s93 offen lds
v_mov_b32 v201, 0x05040100
v_mov_b32 v200, 0x01000504
s_waitcnt lgkmcnt(0)
v_mfma_f32_32x32x16_bf16 v[28:43], v[124:127], v[132:135], v[28:43]
ds_read_b64_tr_b16 v[108:109], v222 offset:8192
ds_read_b64_tr_b16 v[110:111], v222 offset:9216
v_cndmask_b32 v206, v201, v200, s[96:97]
v_mov_b32 v201, 0x07060302
v_mfma_f32_32x32x16_bf16 v[44:59], v[124:127], v[136:139], v[44:59]
ds_read_b64_tr_b16 v[112:113], v223 offset:8192
ds_read_b64_tr_b16 v[114:115], v223 offset:9216
s_add_u32 m0, s84, 0x14c00
s_add_u32 s95, s94, 43008
buffer_load_dwordx4 v246, s[48:51], s95 offen lds
v_mov_b32 v200, 0x03020706
v_mfma_f32_32x32x16_bf16 v[60:75], v[128:131], v[132:135], v[60:75]
ds_read_b128 v[116:119], v4 offset:0
ds_read_b128 v[120:123], v4 offset:4096
v_cndmask_b32 v207, v201, v200, s[96:97]
v_lshlrev_b32 v201, 2, v239
v_mfma_f32_32x32x16_bf16 v[76:91], v[128:131], v[136:139], v[76:91]
s_add_u32 m0, s84, 0x10c00
s_nop 0
buffer_load_dwordx4 v245, s[32:35], s93 offen lds
v_add_u32 v201, v201, v221
v_dot2_f32_bf16 v92, v124, v208, v92
v_dot2_f32_bf16 v93, v125, v208, v93
v_dot2_f32_bf16 v92, v126, v208, v92
v_dot2_f32_bf16 v93, v127, v208, v93
v_lshl_add_u32 v201, v201, 7, v218
v_add_u32 v201, s91, v201
v_lshlrev_b32 v194, 10, v239
v_lshl_add_u32 v194, v238, 2, v194
v_add_u32 v194, s85, v194
s_waitcnt vmcnt(8)
ds_read_b32 v10, v194 offset:128
ds_read_b32 v11, v194 offset:256
ds_read_b32 v12, v194 offset:384
ds_read_b32 v13, v194 offset:512
ds_read_b32 v14, v194 offset:640
ds_read_b32 v15, v194 offset:768
ds_read_b32 v16, v194 offset:896
ds_read_b32 v17, v194 offset:1024
ds_read_b32 v18, v194 offset:1152
ds_read_b32 v19, v194 offset:1280
ds_read_b32 v20, v194 offset:1408
ds_read_b32 v140, v194 offset:3072
ds_read_b32 v141, v194 offset:3200
ds_read_b32 v142, v194 offset:3328
ds_read_b32 v143, v194 offset:3456
ds_read_b32 v144, v194 offset:3584
ds_read_b32 v145, v194 offset:3712
ds_read_b32 v146, v194 offset:3840
ds_read_b32 v147, v194 offset:3968
v_lshlrev_b32 v148, 16, v228
v_lshlrev_b32 v149, 16, v230
v_and_b32 v150, 0xffff0000, v228
v_and_b32 v151, 0xffff0000, v230
v_lshlrev_b32 v152, 16, v229
v_lshlrev_b32 v153, 16, v231
v_and_b32 v154, 0xffff0000, v229
v_and_b32 v155, 0xffff0000, v231
v_lshlrev_b32 v227, 16, v227
v_mul_f32 v227, 0x3fb8aa3b, v227
v_lshlrev_b32 v255, 1, v226
s_lshl_b32 s79, s76, 9
s_sub_u32 s79, 160256, s79
v_add_u32 v255, s79, v255
ds_write_b32 v255, v227
s_lshl_b32 s78, s73, 1
s_sub_u32 s78, 7, s78
v_sub_u32 v255, s78, v239
v_xor_b32 v255, v255, v250
v_lshlrev_b32 v254, 8, v238
v_lshl_add_u32 v236, v255, 4, v254
v_add_u32 v236, 152064, v236
s_waitcnt lgkmcnt(9)
v_lshlrev_b32 v156, 16, v10
v_and_b32 v157, 0xffff0000, v10
v_lshlrev_b32 v158, 16, v11
v_and_b32 v159, 0xffff0000, v11
v_lshlrev_b32 v160, 16, v12
v_and_b32 v161, 0xffff0000, v12
v_lshlrev_b32 v162, 16, v13
v_and_b32 v163, 0xffff0000, v13
v_lshlrev_b32 v164, 16, v14
v_and_b32 v165, 0xffff0000, v14
v_lshlrev_b32 v166, 16, v15
v_and_b32 v167, 0xffff0000, v15
v_lshlrev_b32 v168, 16, v16
v_and_b32 v169, 0xffff0000, v16
v_lshlrev_b32 v170, 16, v17
v_and_b32 v171, 0xffff0000, v17
v_lshlrev_b32 v172, 16, v18
v_and_b32 v173, 0xffff0000, v18
v_lshlrev_b32 v174, 16, v19
v_and_b32 v175, 0xffff0000, v19
v_lshlrev_b32 v176, 16, v20
v_and_b32 v177, 0xffff0000, v20
v_pk_mul_f32 v[10:11], v[162:163], v[148:149]
v_pk_mul_f32 v[12:13], v[164:165], v[148:149]
v_pk_mul_f32 v[14:15], v[166:167], v[148:149]
v_pk_mul_f32 v[16:17], v[168:169], v[148:149]
v_pk_mul_f32 v[18:19], v[170:171], v[148:149]
v_pk_mul_f32 v[20:21], v[172:173], v[148:149]
v_pk_mul_f32 v[22:23], v[174:175], v[148:149]
v_pk_mul_f32 v[24:25], v[176:177], v[148:149]
v_pk_fma_f32 v[10:11], v[160:161], v[150:151], v[10:11]
v_pk_fma_f32 v[12:13], v[162:163], v[150:151], v[12:13]
v_pk_fma_f32 v[14:15], v[164:165], v[150:151], v[14:15]
v_pk_fma_f32 v[16:17], v[166:167], v[150:151], v[16:17]
v_pk_fma_f32 v[18:19], v[168:169], v[150:151], v[18:19]
v_pk_fma_f32 v[20:21], v[170:171], v[150:151], v[20:21]
v_pk_fma_f32 v[22:23], v[172:173], v[150:151], v[22:23]
v_pk_fma_f32 v[24:25], v[174:175], v[150:151], v[24:25]
v_pk_fma_f32 v[10:11], v[158:159], v[152:153], v[10:11]
v_pk_fma_f32 v[12:13], v[160:161], v[152:153], v[12:13]
v_pk_fma_f32 v[14:15], v[162:163], v[152:153], v[14:15]
v_pk_fma_f32 v[16:17], v[164:165], v[152:153], v[16:17]
v_pk_fma_f32 v[18:19], v[166:167], v[152:153], v[18:19]
v_pk_fma_f32 v[20:21], v[168:169], v[152:153], v[20:21]
v_pk_fma_f32 v[22:23], v[170:171], v[152:153], v[22:23]
v_pk_fma_f32 v[24:25], v[172:173], v[152:153], v[24:25]
v_pk_fma_f32 v[10:11], v[156:157], v[154:155], v[10:11]
v_pk_fma_f32 v[12:13], v[158:159], v[154:155], v[12:13]
v_pk_fma_f32 v[14:15], v[160:161], v[154:155], v[14:15]
v_pk_fma_f32 v[16:17], v[162:163], v[154:155], v[16:17]
v_pk_fma_f32 v[18:19], v[164:165], v[154:155], v[18:19]
v_pk_fma_f32 v[20:21], v[166:167], v[154:155], v[20:21]
v_pk_fma_f32 v[22:23], v[168:169], v[154:155], v[22:23]
v_pk_fma_f32 v[24:25], v[170:171], v[154:155], v[24:25]
s_waitcnt lgkmcnt(1)
v_lshlrev_b32 v156, 16, v140
v_and_b32 v157, 0xffff0000, v140
v_pk_mul_f32 v[10:11], v[10:11], v[156:157]
v_lshlrev_b32 v158, 16, v141
v_and_b32 v159, 0xffff0000, v141
v_pk_mul_f32 v[12:13], v[12:13], v[158:159]
v_lshlrev_b32 v160, 16, v142
v_and_b32 v161, 0xffff0000, v142
v_pk_mul_f32 v[14:15], v[14:15], v[160:161]
v_lshlrev_b32 v162, 16, v143
v_and_b32 v163, 0xffff0000, v143
v_pk_mul_f32 v[16:17], v[16:17], v[162:163]
v_lshlrev_b32 v156, 16, v144
v_and_b32 v157, 0xffff0000, v144
v_pk_mul_f32 v[18:19], v[18:19], v[156:157]
v_lshlrev_b32 v158, 16, v145
v_and_b32 v159, 0xffff0000, v145
v_pk_mul_f32 v[20:21], v[20:21], v[158:159]
v_lshlrev_b32 v160, 16, v146
v_and_b32 v161, 0xffff0000, v146
v_pk_mul_f32 v[22:23], v[22:23], v[160:161]
v_lshlrev_b32 v162, 16, v147
v_and_b32 v163, 0xffff0000, v147
v_pk_mul_f32 v[24:25], v[24:25], v[162:163]
v_cvt_pk_bf16_f32 v140, v24, v22
v_cvt_pk_bf16_f32 v141, v20, v18
v_cvt_pk_bf16_f32 v142, v16, v14
v_cvt_pk_bf16_f32 v143, v12, v10
ds_write_b128 v236, v[140:143] offset:0
v_cvt_pk_bf16_f32 v144, v25, v23
v_cvt_pk_bf16_f32 v145, v21, v19
v_cvt_pk_bf16_f32 v146, v17, v15
v_cvt_pk_bf16_f32 v147, v13, v11
ds_write_b128 v236, v[144:147] offset:128
v_mfma_f32_32x32x16_bf16 v[28:43], v[108:111], v[116:119], v[28:43]
ds_read_b64_tr_b16 v[124:125], v222 offset:12288
ds_read_b64_tr_b16 v[126:127], v222 offset:13312
v_lshrrev_b32 v200, 1, v221
v_lshlrev_b32 v200, 2, v200
v_mfma_f32_32x32x16_bf16 v[44:59], v[108:111], v[120:123], v[44:59]
ds_read_b64_tr_b16 v[128:129], v223 offset:12288
ds_read_b64_tr_b16 v[130:131], v223 offset:13312
v_xor_b32 v200, v200, v219
v_mfma_f32_32x32x16_bf16 v[60:75], v[112:115], v[116:119], v[60:75]
ds_read_b128 v[132:135], v5 offset:0
ds_read_b128 v[136:139], v5 offset:4096
s_xor_b32 s0, s86, 0
s_lshl_b32 s0, s0, 2
v_mfma_f32_32x32x16_bf16 v[76:91], v[112:115], v[120:123], v[76:91]
v_xor_b32 v199, s0, v200
v_dot2_f32_bf16 v92, v108, v208, v92
v_dot2_f32_bf16 v93, v109, v208, v93
v_dot2_f32_bf16 v92, v110, v208, v92
v_dot2_f32_bf16 v93, v111, v208, v93
v_lshl_add_u32 v204, v199, 4, v201
s_xor_b32 s0, s86, 1
s_waitcnt lgkmcnt(0)
s_waitcnt lgkmcnt(0)
s_barrier
v_mfma_f32_32x32x16_bf16 v[28:43], v[124:127], v[132:135], v[28:43]
ds_read_b64_tr_b16 v[108:109], v222 offset:32768
ds_read_b64_tr_b16 v[110:111], v222 offset:33792
s_lshl_b32 s0, s0, 2
v_xor_b32 v199, s0, v200
v_mfma_f32_32x32x16_bf16 v[44:59], v[124:127], v[136:139], v[44:59]
ds_read_b64_tr_b16 v[112:113], v223 offset:32768
ds_read_b64_tr_b16 v[114:115], v223 offset:33792
s_add_u32 s93, s93, 128
s_cmp_eq_u32 s93, 896
s_cselect_b32 s93, 0, s93
s_mul_i32 s94, s93, 1792
s_add_u32 m0, s84, 0x4000
s_add_u32 s95, s94, 0
buffer_load_dwordx4 v246, s[48:51], s95 offen lds
v_lshl_add_u32 v205, v199, 4, v201
v_mfma_f32_32x32x16_bf16 v[60:75], v[128:131], v[132:135], v[60:75]
ds_read_b128 v[116:119], v2 offset:32768
ds_read_b128 v[120:123], v2 offset:36864
v_mov_b32 v228, -0.5
v_mov_b32 v229, -0.5
v_mfma_f32_32x32x16_bf16 v[76:91], v[128:131], v[136:139], v[76:91]
s_add_u32 m0, s84, 0x0
s_nop 0
buffer_load_dwordx4 v242, s[32:35], s93 offen lds
v_mov_b32 v230, -1.0
v_dot2_f32_bf16 v92, v124, v208, v92
v_dot2_f32_bf16 v93, v125, v208, v93
v_dot2_f32_bf16 v92, v126, v208, v92
v_dot2_f32_bf16 v93, v127, v208, v93
s_add_u32 m0, s84, 0x4400
s_add_u32 s95, s94, 14336
buffer_load_dwordx4 v246, s[48:51], s95 offen lds
v_mov_b32 v231, -1.0
s_lshl_b32 s0, s75, 2
s_lshl_b32 s78, s73, 11
s_add_u32 s78, s78, 152064
v_add_u32 v255, s78, v237
ds_read_b128 v[140:143], v255 offset:0
ds_read_b128 v[144:147], v255 offset:1024
s_lshl_b32 s78, s72, 2
s_add_u32 s78, s78, s73
s_lshl_b32 s78, s78, 16
s_lshl_b32 s79, s74, 7
s_sub_u32 s78, s78, s79
s_add_u32 s78, s78, 528256
v_lshlrev_b32 v254, 12, v251
v_add_u32 v254, s78, v254
v_xor_b32 v253, v250, v249
v_lshl_add_u32 v192, v253, 4, v254
v_xor_b32 v253, 4, v253
v_lshl_add_u32 v193, v253, 4, v254
v_add_u32 v193, 0x8000, v193
s_waitcnt lgkmcnt(2)
v_mfma_f32_32x32x16_bf16 v[28:43], v[108:111], v[116:119], v[28:43]
ds_read_b64_tr_b16 v[124:125], v222 offset:36864
ds_read_b64_tr_b16 v[126:127], v222 offset:37888
s_lshl_b32 s1, s87, 1
s_add_u32 s0, s0, s1
v_mfma_f32_32x32x16_bf16 v[44:59], v[108:111], v[120:123], v[44:59]
ds_read_b64_tr_b16 v[128:129], v223 offset:36864
ds_read_b64_tr_b16 v[130:131], v223 offset:37888
s_waitcnt lgkmcnt(4)
buffer_store_dwordx4 v[140:143], v192, s[60:63], 0 offen sc1
s_mul_i32 s0, s0, 112
v_mfma_f32_32x32x16_bf16 v[60:75], v[112:115], v[116:119], v[60:75]
ds_read_b128 v[132:135], v3 offset:32768
ds_read_b128 v[136:139], v3 offset:36864
s_lshl_b32 s1, s76, 3
s_add_u32 s0, s0, s1
v_mfma_f32_32x32x16_bf16 v[76:91], v[112:115], v[120:123], v[76:91]
buffer_store_dwordx4 v[144:147], v193, s[60:63], 0 offen sc1
s_lshl_b32 s1, s86, 2
v_dot2_f32_bf16 v92, v108, v208, v92
v_dot2_f32_bf16 v93, v109, v208, v93
v_dot2_f32_bf16 v92, v110, v208, v92
v_dot2_f32_bf16 v93, v111, v208, v93
s_add_u32 m0, s84, 0x400
s_nop 0
buffer_load_dwordx4 v243, s[32:35], s93 offen lds
s_add_u32 s0, s0, s1
s_xor_b32 s1, s87, 0
s_lshl_b32 s79, s89, 3
s_add_u32 s79, s79, s16
s_add_u32 s79, s79, 4
v_add_u32 v194, s79, v237
s_mul_i32 s90, s88, 16640
s_mul_i32 s81, s89, 8320
s_add_u32 s90, s90, s81
s_add_u32 s90, s90, 98368
v_add_u32 v190, v248, v249
v_subrev_u32 v190, 15, v190
v_max_i32 v189, 0, v190
v_lshlrev_b32 v189, 2, v189
v_add_u32 v189, s16, v189
s_lshr_b32 s79, s16, 11
v_mov_b32 v187, s79
s_waitcnt lgkmcnt(0)
v_mfma_f32_32x32x16_bf16 v[28:43], v[124:127], v[132:135], v[28:43]
ds_read_b64_tr_b16 v[108:109], v222 offset:40960
ds_read_b64_tr_b16 v[110:111], v222 offset:41984
s_lshl_b32 s1, s1, 1
s_add_u32 s1, s1, s0
v_mfma_f32_32x32x16_bf16 v[44:59], v[124:127], v[136:139], v[44:59]
ds_read_b64_tr_b16 v[112:113], v223 offset:40960
ds_read_b64_tr_b16 v[114:115], v223 offset:41984
s_add_u32 m0, s84, 0x4800
s_add_u32 s95, s94, 28672
buffer_load_dwordx4 v246, s[48:51], s95 offen lds
s_lshl_b32 s1, s1, 10
v_mfma_f32_32x32x16_bf16 v[60:75], v[128:131], v[132:135], v[60:75]
ds_read_b128 v[116:119], v4 offset:32768
ds_read_b128 v[120:123], v4 offset:36864
s_add_u32 s36, s1, 4198400
s_add_u32 s37, s36, 114688
v_mfma_f32_32x32x16_bf16 v[76:91], v[128:131], v[136:139], v[76:91]
s_add_u32 m0, s84, 0x800
s_nop 0
buffer_load_dwordx4 v244, s[32:35], s93 offen lds
s_xor_b32 s1, s87, 1
v_dot2_f32_bf16 v92, v124, v208, v92
v_dot2_f32_bf16 v93, v125, v208, v93
v_dot2_f32_bf16 v92, v126, v208, v92
v_dot2_f32_bf16 v93, v127, v208, v93
s_add_u32 m0, s84, 0x4c00
s_add_u32 s95, s94, 43008
buffer_load_dwordx4 v246, s[48:51], s95 offen lds
s_lshl_b32 s1, s1, 1
s_add_u32 s1, s1, s0
s_waitcnt lgkmcnt(0)
v_mfma_f32_32x32x16_bf16 v[28:43], v[108:111], v[116:119], v[28:43]
ds_read_b64_tr_b16 v[124:125], v222 offset:45056
ds_read_b64_tr_b16 v[126:127], v222 offset:46080
s_lshl_b32 s1, s1, 10
s_add_u32 s38, s1, 4198400
v_mfma_f32_32x32x16_bf16 v[44:59], v[108:111], v[120:123], v[44:59]
ds_read_b64_tr_b16 v[128:129], v223 offset:45056
ds_read_b64_tr_b16 v[130:131], v223 offset:46080
s_add_u32 m0, s84, 0xc00
s_nop 0
buffer_load_dwordx4 v245, s[32:35], s93 offen lds
s_add_u32 s39, s38, 114688
v_mfma_f32_32x32x16_bf16 v[60:75], v[112:115], v[116:119], v[60:75]
ds_read_b128 v[132:135], v5 offset:32768
ds_read_b128 v[136:139], v5 offset:36864
s_lshl_b32 s0, s86, 8
s_add_u32 s0, s0, 160768
v_mfma_f32_32x32x16_bf16 v[76:91], v[112:115], v[120:123], v[76:91]
s_add_u32 m0, s90, 0x0
s_movk_i32 s95, 0
buffer_load_dwordx4 v194, s[44:47], s95 offen lds
s_lshl_b32 s1, s87, 7
v_dot2_f32_bf16 v92, v108, v208, v92
v_dot2_f32_bf16 v93, v109, v208, v93
v_dot2_f32_bf16 v92, v110, v208, v92
v_dot2_f32_bf16 v93, v111, v208, v93
s_add_u32 m0, s90, 0x400
s_movk_i32 s95, 1024
buffer_load_dwordx4 v194, s[44:47], s95 offen lds
s_add_u32 s1, s1, s0
v_lshlrev_b32 v236, 2, v238
s_waitcnt lgkmcnt(0)
s_waitcnt vmcnt(12)
s_barrier
v_mfma_f32_32x32x16_bf16 v[28:43], v[124:127], v[132:135], v[28:43]
ds_read_b64_tr_b16 v[108:109], v224 offset:0
ds_read_b64_tr_b16 v[110:111], v224 offset:1024
v_add_u32 v236, s1, v236
v_lshlrev_b32 v227, 4, v239
v_mfma_f32_32x32x16_bf16 v[44:59], v[124:127], v[136:139], v[44:59]
ds_read_b64_tr_b16 v[112:113], v225 offset:0
ds_read_b64_tr_b16 v[114:115], v225 offset:1024
s_add_u32 m0, s90, 0x800
s_movk_i32 s95, 2048
buffer_load_dwordx4 v194, s[44:47], s95 offen lds
v_add_u32 v226, s1, v227
v_mfma_f32_32x32x16_bf16 v[60:75], v[128:131], v[132:135], v[60:75]
ds_read_b128 v[116:119], v6 offset:0
ds_read_b128 v[120:123], v6 offset:4096
s_xor_b32 s1, s1, 128
s_sub_u32 s1, s1, s0
v_mfma_f32_32x32x16_bf16 v[76:91], v[128:131], v[136:139], v[76:91]
s_add_u32 m0, s90, 0xc00
s_movk_i32 s95, 3072
buffer_load_dwordx4 v194, s[44:47], s95 offen lds
s_and_b32 s1, s1, 128
v_dot2_f32_bf16 v92, v124, v208, v92
v_dot2_f32_bf16 v93, v125, v208, v93
v_dot2_f32_bf16 v92, v126, v208, v92
v_dot2_f32_bf16 v93, v127, v208, v93
s_add_u32 m0, s90, 0x1040
s_movk_i32 s95, 4
buffer_load_dwordx4 v194, s[44:47], s95 offen lds
s_add_u32 s1, s1, s0
v_add_u32 v227, s1, v227
s_waitcnt lgkmcnt(0)
v_mfma_f32_32x32x16_bf16 v[28:43], v[108:111], v[116:119], v[28:43]
ds_read_b64_tr_b16 v[124:125], v224 offset:4096
ds_read_b64_tr_b16 v[126:127], v224 offset:5120
v_mfma_f32_32x32x16_bf16 v[44:59], v[108:111], v[120:123], v[44:59]
ds_read_b64_tr_b16 v[128:129], v225 offset:4096
ds_read_b64_tr_b16 v[130:131], v225 offset:5120
s_add_u32 m0, s90, 0x1440
s_movk_i32 s95, 1028
buffer_load_dwordx4 v194, s[44:47], s95 offen lds
v_mfma_f32_32x32x16_bf16 v[60:75], v[112:115], v[116:119], v[60:75]
ds_read_b128 v[132:135], v7 offset:0
ds_read_b128 v[136:139], v7 offset:4096
v_mfma_f32_32x32x16_bf16 v[76:91], v[112:115], v[120:123], v[76:91]
s_add_u32 m0, s90, 0x1840
s_movk_i32 s95, 2052
buffer_load_dwordx4 v194, s[44:47], s95 offen lds
v_dot2_f32_bf16 v92, v108, v208, v92
v_dot2_f32_bf16 v93, v109, v208, v93
v_dot2_f32_bf16 v92, v110, v208, v92
v_dot2_f32_bf16 v93, v111, v208, v93
s_add_u32 m0, s90, 0x1c40
s_movk_i32 s95, 3076
buffer_load_dwordx4 v194, s[44:47], s95 offen lds
s_waitcnt lgkmcnt(0)
v_mfma_f32_32x32x16_bf16 v[28:43], v[124:127], v[132:135], v[28:43]
ds_read_b64_tr_b16 v[108:109], v224 offset:8192
ds_read_b64_tr_b16 v[110:111], v224 offset:9216
v_mfma_f32_32x32x16_bf16 v[44:59], v[124:127], v[136:139], v[44:59]
ds_read_b64_tr_b16 v[112:113], v225 offset:8192
ds_read_b64_tr_b16 v[114:115], v225 offset:9216
buffer_load_dword v191, v189, s[44:47], 0 offen
v_mfma_f32_32x32x16_bf16 v[60:75], v[128:131], v[132:135], v[60:75]
ds_read_b128 v[116:119], v8 offset:0
ds_read_b128 v[120:123], v8 offset:4096
v_mfma_f32_32x32x16_bf16 v[76:91], v[128:131], v[136:139], v[76:91]
global_load_ushort v188, v187, s[14:15]
v_dot2_f32_bf16 v92, v124, v208, v92
v_dot2_f32_bf16 v93, v125, v208, v93
v_dot2_f32_bf16 v92, v126, v208, v92
v_dot2_f32_bf16 v93, v127, v208, v93
s_waitcnt lgkmcnt(0)
v_mfma_f32_32x32x16_bf16 v[28:43], v[108:111], v[116:119], v[28:43]
ds_read_b64_tr_b16 v[124:125], v224 offset:12288
ds_read_b64_tr_b16 v[126:127], v224 offset:13312
v_mfma_f32_32x32x16_bf16 v[44:59], v[108:111], v[120:123], v[44:59]
ds_read_b64_tr_b16 v[128:129], v225 offset:12288
ds_read_b64_tr_b16 v[130:131], v225 offset:13312
v_mfma_f32_32x32x16_bf16 v[60:75], v[112:115], v[116:119], v[60:75]
ds_read_b128 v[132:135], v9 offset:0
ds_read_b128 v[136:139], v9 offset:4096
v_mfma_f32_32x32x16_bf16 v[76:91], v[112:115], v[120:123], v[76:91]
v_dot2_f32_bf16 v92, v108, v208, v92
v_dot2_f32_bf16 v93, v109, v208, v93
v_dot2_f32_bf16 v92, v110, v208, v92
v_dot2_f32_bf16 v93, v111, v208, v93
s_waitcnt vmcnt(15)
s_lshl_b32 s78, s72, 2
s_add_u32 s78, s78, s73
s_lshl_b32 s78, s78, 5
s_add_u32 s78, s78, s74
s_lshl_b32 s78, s78, 2
s_add_u32 s78, s78, 8192
v_mov_b32 v255, s78
v_mov_b32 v254, s77
s_mov_b64 exec, 1
buffer_store_dword v254, v255, s[60:63], 0 offen sc1
s_mov_b64 exec, -1
s_waitcnt lgkmcnt(0)
s_waitcnt vmcnt(11)
s_barrier
v_mfma_f32_32x32x16_bf16 v[28:43], v[124:127], v[132:135], v[28:43]
ds_read_b64_tr_b16 v[108:109], v222 offset:0
ds_read_b64_tr_b16 v[110:111], v222 offset:1024
v_mfma_f32_32x32x16_bf16 v[44:59], v[124:127], v[136:139], v[44:59]
ds_read_b64_tr_b16 v[112:113], v223 offset:0
ds_read_b64_tr_b16 v[114:115], v223 offset:1024
v_mfma_f32_32x32x16_bf16 v[60:75], v[128:131], v[132:135], v[60:75]
ds_read_b128 v[116:119], v2 offset:0
ds_read_b128 v[120:123], v2 offset:4096
v_mfma_f32_32x32x16_bf16 v[76:91], v[128:131], v[136:139], v[76:91]
v_dot2_f32_bf16 v92, v124, v208, v92
v_dot2_f32_bf16 v93, v125, v208, v93
v_dot2_f32_bf16 v92, v126, v208, v92
v_dot2_f32_bf16 v93, v127, v208, v93
s_waitcnt lgkmcnt(0)
v_mfma_f32_32x32x16_bf16 v[28:43], v[108:111], v[116:119], v[28:43]
ds_read_b64_tr_b16 v[124:125], v222 offset:4096
ds_read_b64_tr_b16 v[126:127], v222 offset:5120
v_mfma_f32_32x32x16_bf16 v[44:59], v[108:111], v[120:123], v[44:59]
ds_read_b64_tr_b16 v[128:129], v223 offset:4096
ds_read_b64_tr_b16 v[130:131], v223 offset:5120
v_mfma_f32_32x32x16_bf16 v[60:75], v[112:115], v[116:119], v[60:75]
ds_read_b128 v[132:135], v3 offset:0
ds_read_b128 v[136:139], v3 offset:4096
v_mfma_f32_32x32x16_bf16 v[76:91], v[112:115], v[120:123], v[76:91]
v_dot2_f32_bf16 v92, v108, v208, v92
v_dot2_f32_bf16 v93, v109, v208, v93
v_dot2_f32_bf16 v92, v110, v208, v92
v_dot2_f32_bf16 v93, v111, v208, v93
s_lshl_b32 s78, s75, 1
s_add_u32 s78, s78, s87
s_lshl_b32 s78, s78, 10
s_add_u32 s78, s78, 458752
v_lshlrev_b32 v198, 4, v238
v_add_u32 v198, s78, v198
buffer_load_dwordx4 v[10:13], v198, s[60:63], 0 offen offset:0 sc1
buffer_load_dwordx4 v[14:17], v198, s[60:63], 0 offen offset:512 sc1
s_waitcnt lgkmcnt(0)
v_mfma_f32_32x32x16_bf16 v[28:43], v[124:127], v[132:135], v[28:43]
ds_read_b64_tr_b16 v[108:109], v222 offset:8192
ds_read_b64_tr_b16 v[110:111], v222 offset:9216
v_mfma_f32_32x32x16_bf16 v[44:59], v[124:127], v[136:139], v[44:59]
ds_read_b64_tr_b16 v[112:113], v223 offset:8192
ds_read_b64_tr_b16 v[114:115], v223 offset:9216
v_mfma_f32_32x32x16_bf16 v[60:75], v[128:131], v[132:135], v[60:75]
ds_read_b128 v[116:119], v4 offset:0
ds_read_b128 v[120:123], v4 offset:4096
v_mfma_f32_32x32x16_bf16 v[76:91], v[128:131], v[136:139], v[76:91]
v_dot2_f32_bf16 v92, v124, v208, v92
v_dot2_f32_bf16 v93, v125, v208, v93
v_dot2_f32_bf16 v92, v126, v208, v92
v_dot2_f32_bf16 v93, v127, v208, v93
s_waitcnt lgkmcnt(0)
v_mfma_f32_32x32x16_bf16 v[28:43], v[108:111], v[116:119], v[28:43]
ds_read_b64_tr_b16 v[124:125], v222 offset:12288
ds_read_b64_tr_b16 v[126:127], v222 offset:13312
v_mfma_f32_32x32x16_bf16 v[44:59], v[108:111], v[120:123], v[44:59]
ds_read_b64_tr_b16 v[128:129], v223 offset:12288
ds_read_b64_tr_b16 v[130:131], v223 offset:13312
v_mfma_f32_32x32x16_bf16 v[60:75], v[112:115], v[116:119], v[60:75]
ds_read_b128 v[132:135], v5 offset:0
ds_read_b128 v[136:139], v5 offset:4096
v_mfma_f32_32x32x16_bf16 v[76:91], v[112:115], v[120:123], v[76:91]
v_dot2_f32_bf16 v92, v108, v208, v92
v_dot2_f32_bf16 v93, v109, v208, v93
v_dot2_f32_bf16 v92, v110, v208, v92
v_dot2_f32_bf16 v93, v111, v208, v93
s_lshl_b32 s79, s86, 8
s_add_u32 s79, s79, 160256
v_lshlrev_b32 v253, 4, v239
v_add_u32 v253, s79, v253
s_xor_b32 s80, s87, 0
s_lshl_b32 s80, s80, 7
v_add_u32 v252, s80, v253
ds_read_b128 v[140:143], v252 offset:0
ds_read_b128 v[144:147], v252 offset:32
ds_read_b128 v[148:151], v252 offset:64
ds_read_b128 v[152:155], v252 offset:96
s_xor_b32 s80, s87, 1
s_lshl_b32 s80, s80, 7
v_add_u32 v252, s80, v253
ds_read_b128 v[156:159], v252 offset:0
ds_read_b128 v[160:163], v252 offset:32
ds_read_b128 v[164:167], v252 offset:64
ds_read_b128 v[168:171], v252 offset:96
s_waitcnt lgkmcnt(8)
s_barrier
v_mfma_f32_32x32x16_bf16 v[28:43], v[124:127], v[132:135], v[28:43]
v_mfma_f32_32x32x16_bf16 v[44:59], v[124:127], v[136:139], v[44:59]
s_mul_i32 s94, s99, 57344
s_add_u32 m0, s91, 0x0
s_add_u32 s3, s94, 0
buffer_load_dwordx4 v216, s[52:55], s3 offen lds
s_add_u32 m0, s91, 0x400
v_mfma_f32_32x32x16_bf16 v[60:75], v[128:131], v[132:135], v[60:75]
v_mfma_f32_32x32x16_bf16 v[76:91], v[128:131], v[136:139], v[76:91]
buffer_load_dwordx4 v217, s[52:55], s3 offen lds
v_dot2_f32_bf16 v92, v124, v208, v92
v_dot2_f32_bf16 v93, v125, v208, v93
v_dot2_f32_bf16 v92, v126, v208, v92
v_dot2_f32_bf16 v93, v127, v208, v93
s_add_u32 m0, s91, 0x800
s_add_u32 s3, s94, 14336
buffer_load_dwordx4 v216, s[52:55], s3 offen lds
s_add_u32 m0, s91, 0xc00
buffer_load_dword v197, v196, s[60:63], 0 offen sc1
v_add_f32 v92, v92, v93
v_mov_b32 v93, v92
s_nop 1
v_permlane32_swap_b32 v92, v93
v_add_f32 v92, v92, v93
ds_write_b32 v236, v92
s_waitcnt lgkmcnt(0)
s_barrier
ds_read_b128 v[92:95], v226 offset:0
ds_read_b128 v[96:99], v226 offset:32
ds_read_b128 v[100:103], v226 offset:64
ds_read_b128 v[104:107], v226 offset:96
ds_read_b128 v[108:111], v227 offset:0
ds_read_b128 v[112:115], v227 offset:32
ds_read_b128 v[116:119], v227 offset:64
ds_read_b128 v[120:123], v227 offset:96
s_waitcnt vmcnt(4)
v_xor_b32 v255, s77, v11
v_xor_b32 v254, s77, v13
v_or_b32 v255, v255, v254
v_xor_b32 v254, s77, v15
v_or_b32 v255, v255, v254
v_xor_b32 v254, s77, v17
v_or_b32 v255, v255, v254
v_cmp_ne_u32 vcc, 0, v255
s_cbranch_vccz L_stok_1
s_mov_b32 s98, 131072
L_stpoll_2:
buffer_load_dwordx4 v[10:13], v198, s[60:63], 0 offen offset:0 sc1
buffer_load_dwordx4 v[14:17], v198, s[60:63], 0 offen offset:512 sc1
s_waitcnt vmcnt(0)
v_xor_b32 v255, s77, v11
v_xor_b32 v254, s77, v13
v_or_b32 v255, v255, v254
v_xor_b32 v254, s77, v15
v_or_b32 v255, v255, v254
v_xor_b32 v254, s77, v17
v_or_b32 v255, v255, v254
v_cmp_ne_u32 vcc, 0, v255
s_cbranch_vccz L_stok_1
s_sub_u32 s98, s98, 1
s_cbranch_scc0 L_stpoll_2
L_stok_1:
v_mul_f32 v222, 0x3fb8aa3b, v12
v_mul_f32 v223, 0x3fb8aa3b, v16
s_waitcnt lgkmcnt(4)
v_pk_fma_f32 v[2:3], v[10:11], v[92:93], v[28:29] op_sel_hi:[0,1,1] neg_lo:[1,0,0] neg_hi:[1,0,0]
v_pk_fma_f32 v[4:5], v[10:11], v[94:95], v[30:31] op_sel_hi:[0,1,1] neg_lo:[1,0,0] neg_hi:[1,0,0]
v_pk_fma_f32 v[6:7], v[10:11], v[96:97], v[32:33] op_sel_hi:[0,1,1] neg_lo:[1,0,0] neg_hi:[1,0,0]
v_pk_fma_f32 v[8:9], v[10:11], v[98:99], v[34:35] op_sel_hi:[0,1,1] neg_lo:[1,0,0] neg_hi:[1,0,0]
v_pk_fma_f32 v[2:3], v[2:3], v[222:223], v[140:141] op_sel:[0,0,0] op_sel_hi:[1,0,1]
v_pk_fma_f32 v[4:5], v[4:5], v[222:223], v[142:143] op_sel:[0,0,0] op_sel_hi:[1,0,1]
v_pk_fma_f32 v[6:7], v[6:7], v[222:223], v[144:145] op_sel:[0,0,0] op_sel_hi:[1,0,1]
v_pk_fma_f32 v[8:9], v[8:9], v[222:223], v[146:147] op_sel:[0,0,0] op_sel_hi:[1,0,1]
v_exp_f32 v18, v2
v_exp_f32 v19, v3
v_exp_f32 v20, v4
v_exp_f32 v21, v5
buffer_load_dwordx4 v217, s[52:55], s3 offen lds
v_exp_f32 v22, v6
v_exp_f32 v23, v7
v_exp_f32 v24, v8
v_exp_f32 v25, v9
v_pk_fma_f32 v[124:125], v[18:19], v[228:229], v[230:231]
v_pk_fma_f32 v[126:127], v[20:21], v[228:229], v[230:231]
v_pk_fma_f32 v[128:129], v[22:23], v[228:229], v[230:231]
v_pk_fma_f32 v[130:131], v[24:25], v[228:229], v[230:231]
v_pk_fma_f32 v[124:125], v[18:19], v[124:125], v[230:231]
v_pk_fma_f32 v[126:127], v[20:21], v[126:127], v[230:231]
v_pk_fma_f32 v[128:129], v[22:23], v[128:129], v[230:231]
v_pk_fma_f32 v[130:131], v[24:25], v[130:131], v[230:231]
s_add_u32 m0, s91, 0x1000
s_add_u32 s3, s94, 28672
buffer_load_dwordx4 v216, s[52:55], s3 offen lds
s_add_u32 m0, s91, 0x1400
v_rcp_f32 v124, v124
v_rcp_f32 v125, v125
v_rcp_f32 v126, v126
v_rcp_f32 v127, v127
v_rcp_f32 v128, v128
v_rcp_f32 v129, v129
buffer_load_dwordx4 v217, s[52:55], s3 offen lds
v_rcp_f32 v130, v130
v_rcp_f32 v131, v131
v_pk_fma_f32 v[2:3], v[2:3], v[124:125], v[2:3]
v_pk_fma_f32 v[4:5], v[4:5], v[126:127], v[4:5]
v_pk_fma_f32 v[6:7], v[6:7], v[128:129], v[6:7]
v_pk_fma_f32 v[8:9], v[8:9], v[130:131], v[8:9]
v_cvt_pk_bf16_f32 v132, v2, v3
v_cvt_pk_bf16_f32 v133, v4, v5
v_cvt_pk_bf16_f32 v134, v6, v7
v_cvt_pk_bf16_f32 v135, v8, v9
buffer_store_dwordx4 v[132:135], v237, s[60:63], s36 offen offset:0 sc1
v_pk_fma_f32 v[2:3], v[10:11], v[100:101], v[36:37] op_sel_hi:[0,1,1] neg_lo:[1,0,0] neg_hi:[1,0,0]
v_pk_fma_f32 v[4:5], v[10:11], v[102:103], v[38:39] op_sel_hi:[0,1,1] neg_lo:[1,0,0] neg_hi:[1,0,0]
v_pk_fma_f32 v[6:7], v[10:11], v[104:105], v[40:41] op_sel_hi:[0,1,1] neg_lo:[1,0,0] neg_hi:[1,0,0]
v_pk_fma_f32 v[8:9], v[10:11], v[106:107], v[42:43] op_sel_hi:[0,1,1] neg_lo:[1,0,0] neg_hi:[1,0,0]
v_pk_fma_f32 v[2:3], v[2:3], v[222:223], v[148:149] op_sel:[0,0,0] op_sel_hi:[1,0,1]
v_pk_fma_f32 v[4:5], v[4:5], v[222:223], v[150:151] op_sel:[0,0,0] op_sel_hi:[1,0,1]
v_pk_fma_f32 v[6:7], v[6:7], v[222:223], v[152:153] op_sel:[0,0,0] op_sel_hi:[1,0,1]
v_pk_fma_f32 v[8:9], v[8:9], v[222:223], v[154:155] op_sel:[0,0,0] op_sel_hi:[1,0,1]
v_exp_f32 v18, v2
v_exp_f32 v19, v3
v_exp_f32 v20, v4
v_exp_f32 v21, v5
s_add_u32 m0, s91, 0x1800
s_add_u32 s3, s94, 43008
buffer_load_dwordx4 v216, s[52:55], s3 offen lds
s_add_u32 m0, s91, 0x1c00
v_exp_f32 v22, v6
v_exp_f32 v23, v7
v_exp_f32 v24, v8
v_exp_f32 v25, v9
v_pk_fma_f32 v[124:125], v[18:19], v[228:229], v[230:231]
v_pk_fma_f32 v[126:127], v[20:21], v[228:229], v[230:231]
v_pk_fma_f32 v[128:129], v[22:23], v[228:229], v[230:231]
v_pk_fma_f32 v[130:131], v[24:25], v[228:229], v[230:231]
v_pk_fma_f32 v[124:125], v[18:19], v[124:125], v[230:231]
v_pk_fma_f32 v[126:127], v[20:21], v[126:127], v[230:231]
v_pk_fma_f32 v[128:129], v[22:23], v[128:129], v[230:231]
v_pk_fma_f32 v[130:131], v[24:25], v[130:131], v[230:231]
buffer_load_dwordx4 v217, s[52:55], s3 offen lds
v_rcp_f32 v124, v124
v_rcp_f32 v125, v125
v_rcp_f32 v126, v126
v_rcp_f32 v127, v127
v_rcp_f32 v128, v128
v_rcp_f32 v129, v129
s_add_u32 s94, s94, 57344
s_cmp_eq_u32 s94, 401408
s_cselect_b32 s94, 0, s94
s_add_u32 m0, s91, 0x2000
s_add_u32 s3, s94, 0
buffer_load_dwordx4 v216, s[52:55], s3 offen lds
s_add_u32 m0, s91, 0x2400
v_rcp_f32 v130, v130
v_rcp_f32 v131, v131
v_pk_fma_f32 v[2:3], v[2:3], v[124:125], v[2:3]
v_pk_fma_f32 v[4:5], v[4:5], v[126:127], v[4:5]
v_pk_fma_f32 v[6:7], v[6:7], v[128:129], v[6:7]
v_pk_fma_f32 v[8:9], v[8:9], v[130:131], v[8:9]
v_cvt_pk_bf16_f32 v136, v2, v3
v_cvt_pk_bf16_f32 v137, v4, v5
v_cvt_pk_bf16_f32 v138, v6, v7
v_cvt_pk_bf16_f32 v139, v8, v9
buffer_store_dwordx4 v[136:139], v237, s[60:63], s36 offen offset:1024 sc1
s_waitcnt vmcnt(8)
v_cmp_ne_u32 vcc, s77, v197
s_cbranch_vccz L_flagok_3
s_mov_b32 s98, 131072
L_flagpoll_4:
buffer_load_dword v197, v196, s[60:63], 0 offen sc1
s_waitcnt vmcnt(0)
v_cmp_ne_u32 vcc, s77, v197
s_cbranch_vccz L_flagok_3
s_sub_u32 s98, s98, 1
s_cbranch_scc0 L_flagpoll_4
L_flagok_3:
v_sub_u32 v246, v195, v237
v_pk_fma_f32 v[2:3], v[14:15], v[92:93], v[44:45] op_sel_hi:[0,1,1] neg_lo:[1,0,0] neg_hi:[1,0,0]
v_pk_fma_f32 v[4:5], v[14:15], v[94:95], v[46:47] op_sel_hi:[0,1,1] neg_lo:[1,0,0] neg_hi:[1,0,0]
v_pk_fma_f32 v[6:7], v[14:15], v[96:97], v[48:49] op_sel_hi:[0,1,1] neg_lo:[1,0,0] neg_hi:[1,0,0]
v_pk_fma_f32 v[8:9], v[14:15], v[98:99], v[50:51] op_sel_hi:[0,1,1] neg_lo:[1,0,0] neg_hi:[1,0,0]
v_pk_fma_f32 v[2:3], v[2:3], v[222:223], v[140:141] op_sel:[0,1,0] op_sel_hi:[1,1,1]
v_pk_fma_f32 v[4:5], v[4:5], v[222:223], v[142:143] op_sel:[0,1,0] op_sel_hi:[1,1,1]
v_pk_fma_f32 v[6:7], v[6:7], v[222:223], v[144:145] op_sel:[0,1,0] op_sel_hi:[1,1,1]
v_pk_fma_f32 v[8:9], v[8:9], v[222:223], v[146:147] op_sel:[0,1,0] op_sel_hi:[1,1,1]
v_exp_f32 v18, v2
v_exp_f32 v19, v3
v_exp_f32 v20, v4
v_exp_f32 v21, v5
buffer_load_dwordx4 v217, s[52:55], s3 offen lds
v_exp_f32 v22, v6
v_exp_f32 v23, v7
v_exp_f32 v24, v8
v_exp_f32 v25, v9
v_pk_fma_f32 v[124:125], v[18:19], v[228:229], v[230:231]
v_pk_fma_f32 v[126:127], v[20:21], v[228:229], v[230:231]
v_pk_fma_f32 v[128:129], v[22:23], v[228:229], v[230:231]
v_pk_fma_f32 v[130:131], v[24:25], v[228:229], v[230:231]
v_pk_fma_f32 v[124:125], v[18:19], v[124:125], v[230:231]
v_pk_fma_f32 v[126:127], v[20:21], v[126:127], v[230:231]
v_pk_fma_f32 v[128:129], v[22:23], v[128:129], v[230:231]
v_pk_fma_f32 v[130:131], v[24:25], v[130:131], v[230:231]
buffer_load_dwordx4 v[242:245], v195, s[60:63], 0 offen offset:0 sc1
v_rcp_f32 v124, v124
v_rcp_f32 v125, v125
v_rcp_f32 v126, v126
v_rcp_f32 v127, v127
v_rcp_f32 v128, v128
v_rcp_f32 v129, v129
buffer_load_dwordx4 v[232:235], v195, s[60:63], 0 offen offset:1024 sc1
v_rcp_f32 v130, v130
v_rcp_f32 v131, v131
v_pk_fma_f32 v[2:3], v[2:3], v[124:125], v[2:3]
v_pk_fma_f32 v[4:5], v[4:5], v[126:127], v[4:5]
v_pk_fma_f32 v[6:7], v[6:7], v[128:129], v[6:7]
v_pk_fma_f32 v[8:9], v[8:9], v[130:131], v[8:9]
v_cvt_pk_bf16_f32 v132, v2, v3
v_cvt_pk_bf16_f32 v133, v4, v5
v_cvt_pk_bf16_f32 v134, v6, v7
v_cvt_pk_bf16_f32 v135, v8, v9
buffer_store_dwordx4 v[132:135], v237, s[60:63], s37 offen offset:0 sc1
v_pk_fma_f32 v[2:3], v[14:15], v[100:101], v[52:53] op_sel_hi:[0,1,1] neg_lo:[1,0,0] neg_hi:[1,0,0]
v_pk_fma_f32 v[4:5], v[14:15], v[102:103], v[54:55] op_sel_hi:[0,1,1] neg_lo:[1,0,0] neg_hi:[1,0,0]
v_pk_fma_f32 v[6:7], v[14:15], v[104:105], v[56:57] op_sel_hi:[0,1,1] neg_lo:[1,0,0] neg_hi:[1,0,0]
v_pk_fma_f32 v[8:9], v[14:15], v[106:107], v[58:59] op_sel_hi:[0,1,1] neg_lo:[1,0,0] neg_hi:[1,0,0]
v_pk_fma_f32 v[2:3], v[2:3], v[222:223], v[148:149] op_sel:[0,1,0] op_sel_hi:[1,1,1]
v_pk_fma_f32 v[4:5], v[4:5], v[222:223], v[150:151] op_sel:[0,1,0] op_sel_hi:[1,1,1]
v_pk_fma_f32 v[6:7], v[6:7], v[222:223], v[152:153] op_sel:[0,1,0] op_sel_hi:[1,1,1]
v_pk_fma_f32 v[8:9], v[8:9], v[222:223], v[154:155] op_sel:[0,1,0] op_sel_hi:[1,1,1]
v_exp_f32 v18, v2
v_exp_f32 v19, v3
v_exp_f32 v20, v4
v_exp_f32 v21, v5
buffer_load_dword v225, v246, s[60:63], 0 offen offset:2048 sc1
v_exp_f32 v22, v6
v_exp_f32 v23, v7
v_exp_f32 v24, v8
v_exp_f32 v25, v9
v_pk_fma_f32 v[124:125], v[18:19], v[228:229], v[230:231]
v_pk_fma_f32 v[126:127], v[20:21], v[228:229], v[230:231]
v_pk_fma_f32 v[128:129], v[22:23], v[228:229], v[230:231]
v_pk_fma_f32 v[130:131], v[24:25], v[228:229], v[230:231]
v_pk_fma_f32 v[124:125], v[18:19], v[124:125], v[230:231]
v_pk_fma_f32 v[126:127], v[20:21], v[126:127], v[230:231]
v_pk_fma_f32 v[128:129], v[22:23], v[128:129], v[230:231]
v_pk_fma_f32 v[130:131], v[24:25], v[130:131], v[230:231]
s_add_u32 m0, s91, 0x2800
s_add_u32 s3, s94, 14336
buffer_load_dwordx4 v216, s[52:55], s3 offen lds
s_add_u32 m0, s91, 0x2c00
v_rcp_f32 v124, v124
v_rcp_f32 v125, v125
v_rcp_f32 v126, v126
v_rcp_f32 v127, v127
v_rcp_f32 v128, v128
v_rcp_f32 v129, v129
buffer_load_dwordx4 v217, s[52:55], s3 offen lds
v_rcp_f32 v130, v130
v_rcp_f32 v131, v131
v_pk_fma_f32 v[2:3], v[2:3], v[124:125], v[2:3]
v_pk_fma_f32 v[4:5], v[4:5], v[126:127], v[4:5]
v_pk_fma_f32 v[6:7], v[6:7], v[128:129], v[6:7]
v_pk_fma_f32 v[8:9], v[8:9], v[130:131], v[8:9]
v_cvt_pk_bf16_f32 v136, v2, v3
v_cvt_pk_bf16_f32 v137, v4, v5
v_cvt_pk_bf16_f32 v138, v6, v7
v_cvt_pk_bf16_f32 v139, v8, v9
buffer_store_dwordx4 v[136:139], v237, s[60:63], s37 offen offset:1024 sc1
s_waitcnt lgkmcnt(0)
v_pk_fma_f32 v[2:3], v[10:11], v[108:109], v[60:61] op_sel_hi:[0,1,1] neg_lo:[1,0,0] neg_hi:[1,0,0]
v_pk_fma_f32 v[4:5], v[10:11], v[110:111], v[62:63] op_sel_hi:[0,1,1] neg_lo:[1,0,0] neg_hi:[1,0,0]
v_pk_fma_f32 v[6:7], v[10:11], v[112:113], v[64:65] op_sel_hi:[0,1,1] neg_lo:[1,0,0] neg_hi:[1,0,0]
v_pk_fma_f32 v[8:9], v[10:11], v[114:115], v[66:67] op_sel_hi:[0,1,1] neg_lo:[1,0,0] neg_hi:[1,0,0]
v_pk_fma_f32 v[2:3], v[2:3], v[222:223], v[156:157] op_sel:[0,0,0] op_sel_hi:[1,0,1]
v_pk_fma_f32 v[4:5], v[4:5], v[222:223], v[158:159] op_sel:[0,0,0] op_sel_hi:[1,0,1]
v_pk_fma_f32 v[6:7], v[6:7], v[222:223], v[160:161] op_sel:[0,0,0] op_sel_hi:[1,0,1]
v_pk_fma_f32 v[8:9], v[8:9], v[222:223], v[162:163] op_sel:[0,0,0] op_sel_hi:[1,0,1]
v_exp_f32 v18, v2
v_exp_f32 v19, v3
v_exp_f32 v20, v4
v_exp_f32 v21, v5
s_add_u32 m0, s91, 0x3000
s_add_u32 s3, s94, 28672
buffer_load_dwordx4 v216, s[52:55], s3 offen lds
s_add_u32 m0, s91, 0x3400
v_exp_f32 v22, v6
v_exp_f32 v23, v7
v_exp_f32 v24, v8
v_exp_f32 v25, v9
v_pk_fma_f32 v[124:125], v[18:19], v[228:229], v[230:231]
v_pk_fma_f32 v[126:127], v[20:21], v[228:229], v[230:231]
v_pk_fma_f32 v[128:129], v[22:23], v[228:229], v[230:231]
v_pk_fma_f32 v[130:131], v[24:25], v[228:229], v[230:231]
v_pk_fma_f32 v[124:125], v[18:19], v[124:125], v[230:231]
v_pk_fma_f32 v[126:127], v[20:21], v[126:127], v[230:231]
v_pk_fma_f32 v[128:129], v[22:23], v[128:129], v[230:231]
v_pk_fma_f32 v[130:131], v[24:25], v[130:131], v[230:231]
buffer_load_dwordx4 v217, s[52:55], s3 offen lds
v_rcp_f32 v124, v124
v_rcp_f32 v125, v125
v_rcp_f32 v126, v126
v_rcp_f32 v127, v127
v_rcp_f32 v128, v128
v_rcp_f32 v129, v129
s_add_u32 m0, s91, 0x3800
s_add_u32 s3, s94, 43008
buffer_load_dwordx4 v216, s[52:55], s3 offen lds
s_add_u32 m0, s91, 0x3c00
v_rcp_f32 v130, v130
v_rcp_f32 v131, v131
v_pk_fma_f32 v[2:3], v[2:3], v[124:125], v[2:3]
v_pk_fma_f32 v[4:5], v[4:5], v[126:127], v[4:5]
v_pk_fma_f32 v[6:7], v[6:7], v[128:129], v[6:7]
v_pk_fma_f32 v[8:9], v[8:9], v[130:131], v[8:9]
v_cvt_pk_bf16_f32 v132, v2, v3
v_cvt_pk_bf16_f32 v133, v4, v5
v_cvt_pk_bf16_f32 v134, v6, v7
v_cvt_pk_bf16_f32 v135, v8, v9
buffer_store_dwordx4 v[132:135], v237, s[60:63], s38 offen offset:0 sc1
v_pk_fma_f32 v[2:3], v[10:11], v[116:117], v[68:69] op_sel_hi:[0,1,1] neg_lo:[1,0,0] neg_hi:[1,0,0]
v_pk_fma_f32 v[4:5], v[10:11], v[118:119], v[70:71] op_sel_hi:[0,1,1] neg_lo:[1,0,0] neg_hi:[1,0,0]
v_pk_fma_f32 v[6:7], v[10:11], v[120:121], v[72:73] op_sel_hi:[0,1,1] neg_lo:[1,0,0] neg_hi:[1,0,0]
v_pk_fma_f32 v[8:9], v[10:11], v[122:123], v[74:75] op_sel_hi:[0,1,1] neg_lo:[1,0,0] neg_hi:[1,0,0]
v_pk_fma_f32 v[2:3], v[2:3], v[222:223], v[164:165] op_sel:[0,0,0] op_sel_hi:[1,0,1]
v_pk_fma_f32 v[4:5], v[4:5], v[222:223], v[166:167] op_sel:[0,0,0] op_sel_hi:[1,0,1]
v_pk_fma_f32 v[6:7], v[6:7], v[222:223], v[168:169] op_sel:[0,0,0] op_sel_hi:[1,0,1]
v_pk_fma_f32 v[8:9], v[8:9], v[222:223], v[170:171] op_sel:[0,0,0] op_sel_hi:[1,0,1]
v_exp_f32 v18, v2
v_exp_f32 v19, v3
v_exp_f32 v20, v4
v_exp_f32 v21, v5
buffer_load_dwordx4 v217, s[52:55], s3 offen lds
v_exp_f32 v22, v6
v_exp_f32 v23, v7
v_exp_f32 v24, v8
v_exp_f32 v25, v9
v_pk_fma_f32 v[124:125], v[18:19], v[228:229], v[230:231]
v_pk_fma_f32 v[126:127], v[20:21], v[228:229], v[230:231]
v_pk_fma_f32 v[128:129], v[22:23], v[228:229], v[230:231]
v_pk_fma_f32 v[130:131], v[24:25], v[228:229], v[230:231]
v_pk_fma_f32 v[124:125], v[18:19], v[124:125], v[230:231]
v_pk_fma_f32 v[126:127], v[20:21], v[126:127], v[230:231]
v_pk_fma_f32 v[128:129], v[22:23], v[128:129], v[230:231]
v_pk_fma_f32 v[130:131], v[24:25], v[130:131], v[230:231]
v_rcp_f32 v124, v124
v_rcp_f32 v125, v125
v_rcp_f32 v126, v126
v_rcp_f32 v127, v127
v_rcp_f32 v128, v128
v_rcp_f32 v129, v129
v_rcp_f32 v130, v130
v_rcp_f32 v131, v131
v_pk_fma_f32 v[2:3], v[2:3], v[124:125], v[2:3]
v_pk_fma_f32 v[4:5], v[4:5], v[126:127], v[4:5]
v_pk_fma_f32 v[6:7], v[6:7], v[128:129], v[6:7]
v_pk_fma_f32 v[8:9], v[8:9], v[130:131], v[8:9]
v_cvt_pk_bf16_f32 v136, v2, v3
v_cvt_pk_bf16_f32 v137, v4, v5
v_cvt_pk_bf16_f32 v138, v6, v7
v_cvt_pk_bf16_f32 v139, v8, v9
buffer_store_dwordx4 v[136:139], v237, s[60:63], s38 offen offset:1024 sc1
v_pk_fma_f32 v[2:3], v[14:15], v[108:109], v[76:77] op_sel_hi:[0,1,1] neg_lo:[1,0,0] neg_hi:[1,0,0]
v_pk_fma_f32 v[4:5], v[14:15], v[110:111], v[78:79] op_sel_hi:[0,1,1] neg_lo:[1,0,0] neg_hi:[1,0,0]
v_pk_fma_f32 v[6:7], v[14:15], v[112:113], v[80:81] op_sel_hi:[0,1,1] neg_lo:[1,0,0] neg_hi:[1,0,0]
v_pk_fma_f32 v[8:9], v[14:15], v[114:115], v[82:83] op_sel_hi:[0,1,1] neg_lo:[1,0,0] neg_hi:[1,0,0]
v_pk_fma_f32 v[2:3], v[2:3], v[222:223], v[156:157] op_sel:[0,1,0] op_sel_hi:[1,1,1]
v_pk_fma_f32 v[4:5], v[4:5], v[222:223], v[158:159] op_sel:[0,1,0] op_sel_hi:[1,1,1]
v_pk_fma_f32 v[6:7], v[6:7], v[222:223], v[160:161] op_sel:[0,1,0] op_sel_hi:[1,1,1]
v_pk_fma_f32 v[8:9], v[8:9], v[222:223], v[162:163] op_sel:[0,1,0] op_sel_hi:[1,1,1]
v_exp_f32 v18, v2
v_exp_f32 v19, v3
v_exp_f32 v20, v4
v_exp_f32 v21, v5
v_exp_f32 v22, v6
v_exp_f32 v23, v7
v_exp_f32 v24, v8
v_exp_f32 v25, v9
v_pk_fma_f32 v[124:125], v[18:19], v[228:229], v[230:231]
v_pk_fma_f32 v[126:127], v[20:21], v[228:229], v[230:231]
v_pk_fma_f32 v[128:129], v[22:23], v[228:229], v[230:231]
v_pk_fma_f32 v[130:131], v[24:25], v[228:229], v[230:231]
v_pk_fma_f32 v[124:125], v[18:19], v[124:125], v[230:231]
v_pk_fma_f32 v[126:127], v[20:21], v[126:127], v[230:231]
v_pk_fma_f32 v[128:129], v[22:23], v[128:129], v[230:231]
v_pk_fma_f32 v[130:131], v[24:25], v[130:131], v[230:231]
v_rcp_f32 v124, v124
v_rcp_f32 v125, v125
v_rcp_f32 v126, v126
v_rcp_f32 v127, v127
v_rcp_f32 v128, v128
v_rcp_f32 v129, v129
v_rcp_f32 v130, v130
v_rcp_f32 v131, v131
v_pk_fma_f32 v[2:3], v[2:3], v[124:125], v[2:3]
v_pk_fma_f32 v[4:5], v[4:5], v[126:127], v[4:5]
v_pk_fma_f32 v[6:7], v[6:7], v[128:129], v[6:7]
v_pk_fma_f32 v[8:9], v[8:9], v[130:131], v[8:9]
v_cvt_pk_bf16_f32 v132, v2, v3
v_cvt_pk_bf16_f32 v133, v4, v5
v_cvt_pk_bf16_f32 v134, v6, v7
v_cvt_pk_bf16_f32 v135, v8, v9
buffer_store_dwordx4 v[132:135], v237, s[60:63], s39 offen offset:0 sc1
s_waitcnt vmcnt(10)
v_readfirstlane_b32 s79, v232
s_cmp_eq_u32 s89, 1
s_cselect_b32 s78, 0, -1
v_and_b32 v225, s78, v225
v_mov_b32 v246, s79
v_mov_b32_dpp v225, v232 wave_shl:1 row_mask:0xf bank_mask:0xf
v_mov_b32_dpp v246, v242 wave_shl:1 row_mask:0xf bank_mask:0xf
ds_write_b128 v203, v[242:245] offset:4640
v_alignbit_b32 v208, v243, v242, 16
v_alignbit_b32 v209, v244, v243, 16
v_alignbit_b32 v210, v245, v244, 16
v_alignbit_b32 v211, v246, v245, 16
ds_write_b128 v203, v[208:211] offset:0
s_nop 0
ds_write_b128 v203, v[232:235] offset:5664
v_alignbit_b32 v208, v233, v232, 16
v_alignbit_b32 v209, v234, v233, 16
v_alignbit_b32 v210, v235, v234, 16
v_alignbit_b32 v211, v225, v235, 16
ds_write_b128 v203, v[208:211] offset:1024
s_nop 0
v_mov_b32 v208, 0
v_mov_b32 v209, 0
v_mov_b32 v210, 0
v_mov_b32 v211, 0
s_mul_i32 s78, s89, 2592
v_add_u32 v255, s78, v203
s_mov_b32 exec_hi, 0
ds_write_b128 v255, v[208:211] offset:4096
s_mov_b64 exec, -1
v_cmp_gt_i32 vcc, 0, v190
s_nop 1
v_cndmask_b32 v191, v191, v240, vcc
ds_write_b32 v202, v191
v_lshlrev_b32 v188, 16, v188
v_pk_fma_f32 v[2:3], v[14:15], v[116:117], v[84:85] op_sel_hi:[0,1,1] neg_lo:[1,0,0] neg_hi:[1,0,0]
v_pk_fma_f32 v[4:5], v[14:15], v[118:119], v[86:87] op_sel_hi:[0,1,1] neg_lo:[1,0,0] neg_hi:[1,0,0]
v_pk_fma_f32 v[6:7], v[14:15], v[120:121], v[88:89] op_sel_hi:[0,1,1] neg_lo:[1,0,0] neg_hi:[1,0,0]
v_pk_fma_f32 v[8:9], v[14:15], v[122:123], v[90:91] op_sel_hi:[0,1,1] neg_lo:[1,0,0] neg_hi:[1,0,0]
v_pk_fma_f32 v[2:3], v[2:3], v[222:223], v[164:165] op_sel:[0,1,0] op_sel_hi:[1,1,1]
v_pk_fma_f32 v[4:5], v[4:5], v[222:223], v[166:167] op_sel:[0,1,0] op_sel_hi:[1,1,1]
v_pk_fma_f32 v[6:7], v[6:7], v[222:223], v[168:169] op_sel:[0,1,0] op_sel_hi:[1,1,1]
v_pk_fma_f32 v[8:9], v[8:9], v[222:223], v[170:171] op_sel:[0,1,0] op_sel_hi:[1,1,1]
v_exp_f32 v18, v2
v_exp_f32 v19, v3
v_exp_f32 v20, v4
v_exp_f32 v21, v5
v_exp_f32 v22, v6
v_exp_f32 v23, v7
v_exp_f32 v24, v8
v_exp_f32 v25, v9
v_pk_fma_f32 v[124:125], v[18:19], v[228:229], v[230:231]
v_pk_fma_f32 v[126:127], v[20:21], v[228:229], v[230:231]
v_pk_fma_f32 v[128:129], v[22:23], v[228:229], v[230:231]
v_pk_fma_f32 v[130:131], v[24:25], v[228:229], v[230:231]
v_pk_fma_f32 v[124:125], v[18:19], v[124:125], v[230:231]
v_pk_fma_f32 v[126:127], v[20:21], v[126:127], v[230:231]
v_pk_fma_f32 v[128:129], v[22:23], v[128:129], v[230:231]
v_pk_fma_f32 v[130:131], v[24:25], v[130:131], v[230:231]
v_rcp_f32 v124, v124
v_rcp_f32 v125, v125
v_rcp_f32 v126, v126
v_rcp_f32 v127, v127
v_rcp_f32 v128, v128
v_rcp_f32 v129, v129
v_rcp_f32 v130, v130
v_rcp_f32 v131, v131
v_pk_fma_f32 v[2:3], v[2:3], v[124:125], v[2:3]
v_pk_fma_f32 v[4:5], v[4:5], v[126:127], v[4:5]
v_pk_fma_f32 v[6:7], v[6:7], v[128:129], v[6:7]
v_pk_fma_f32 v[8:9], v[8:9], v[130:131], v[8:9]
v_cvt_pk_bf16_f32 v136, v2, v3
v_cvt_pk_bf16_f32 v137, v4, v5
v_cvt_pk_bf16_f32 v138, v6, v7
v_cvt_pk_bf16_f32 v139, v8, v9
buffer_store_dwordx4 v[136:139], v237, s[60:63], s39 offen offset:1024 sc1
s_mul_i32 s78, s73, 7
s_lshl_b32 s79, s74, 5
s_add_u32 s78, s78, s79
v_min_u32 v255, 6, v1
v_add_u32 v255, s78, v255
v_lshlrev_b32 v255, 2, v255
v_add_u32 v198, 16384, v255
s_mov_b32 s42, s86
s_mov_b32 s43, s87
s_xor_b32 s78, s43, 0
s_lshl_b32 s79, s74, 1
s_add_u32 s78, s78, s79
s_mul_i32 s78, s78, 112
s_mul_i32 s79, s73, 28
s_add_u32 s78, s78, s79
s_lshl_b32 s78, s78, 10
s_add_u32 s40, s78, 4198400
s_xor_b32 s78, s43, 1
s_lshl_b32 s79, s74, 1
s_add_u32 s78, s78, s79
s_mul_i32 s78, s78, 112
s_mul_i32 s79, s73, 28
s_add_u32 s78, s78, s79
s_lshl_b32 s78, s78, 10
s_add_u32 s41, s78, 4198400
s_waitcnt lgkmcnt(0)
s_barrier
s_lshl_b32 s79, s74, 1
s_add_u32 s79, s79, s43
s_lshl_b32 s79, s79, 5
v_add_u32 v246, s79, v238
s_lshl_b32 s78, s72, 6
s_lshl_b32 s79, s42, 5
s_add_u32 s78, s78, s79
s_lshl_b32 s78, s78, 1
v_mul_u32_u24 v245, 896, v246
v_add_u32 v245, s78, v245
v_lshl_add_u32 v252, v239, 4, v245
ds_read_b128 v[36:39], v241 offset:0
ds_read_b128 v[100:103], v215 offset:3584
ds_read_b128 v[40:43], v241 offset:512
ds_read_b128 v[104:107], v215 offset:3072
ds_read_b128 v[44:47], v241 offset:1024
ds_read_b128 v[108:111], v215 offset:2560
ds_read_b128 v[48:51], v241 offset:1536
ds_read_b128 v[112:115], v215 offset:2048
ds_read_b128 v[52:55], v241 offset:2048
ds_read_b128 v[116:119], v215 offset:1536
ds_read_b128 v[56:59], v241 offset:2560
ds_read_b128 v[120:123], v215 offset:1024
ds_read_b128 v[60:63], v241 offset:3072
ds_read_b128 v[124:127], v215 offset:512
ds_read_b128 v[64:67], v241 offset:3584
ds_read_b128 v[128:131], v215 offset:0
s_waitcnt lgkmcnt(14)
v_mfma_f32_16x16x32_bf16 v[4:7], v[36:39], v[100:103], 0
s_waitcnt lgkmcnt(12)
v_mfma_f32_16x16x32_bf16 v[8:11], v[36:39], v[104:107], 0
v_mfma_f32_16x16x32_bf16 v[8:11], v[40:43], v[100:103], v[8:11]
ds_read_b128 v[68:71], v241 offset:64
v_mfma_f32_16x16x32_bf16 v[12:15], v[40:43], v[104:107], 0
s_add_u32 s94, s94, 57344
s_cmp_eq_u32 s94, 401408
s_cselect_b32 s94, 0, s94
s_add_u32 m0, s91, 0x4000
s_add_u32 s3, s94, 0
buffer_load_dwordx4 v216, s[52:55], s3 offen lds
s_add_u32 m0, s91, 0x4400
s_waitcnt lgkmcnt(11)
v_mfma_f32_16x16x32_bf16 v[12:15], v[36:39], v[108:111], v[12:15]
ds_read_b128 v[132:135], v215 offset:3648
ds_read_b64_tr_b16 a[0:1], v204 offset:0
ds_read_b64_tr_b16 a[2:3], v204 offset:1024
ds_read_b64_tr_b16 a[4:5], v205 offset:0
ds_read_b64_tr_b16 a[6:7], v205 offset:1024
v_mfma_f32_16x16x32_bf16 v[16:19], v[40:43], v[108:111], 0
v_mfma_f32_16x16x32_bf16 v[12:15], v[44:47], v[100:103], v[12:15]
ds_read_b128 v[72:75], v241 offset:576
v_mfma_f32_16x16x32_bf16 v[16:19], v[44:47], v[104:107], v[16:19]
buffer_load_dwordx4 v217, s[52:55], s3 offen lds
v_mfma_f32_16x16x32_bf16 v[20:23], v[44:47], v[108:111], 0
ds_read_b128 v[136:139], v215 offset:3136
v_mfma_f32_16x16x32_bf16 v[16:19], v[36:39], v[112:115], v[16:19]
v_mfma_f32_16x16x32_bf16 v[20:23], v[40:43], v[112:115], v[20:23]
ds_read_b128 v[76:79], v241 offset:1088
v_mfma_f32_16x16x32_bf16 v[24:27], v[44:47], v[112:115], 0
s_add_u32 m0, s91, 0x4800
s_add_u32 s3, s94, 14336
buffer_load_dwordx4 v216, s[52:55], s3 offen lds
s_add_u32 m0, s91, 0x4c00
v_mfma_f32_16x16x32_bf16 v[16:19], v[48:51], v[100:103], v[16:19]
ds_read_b128 v[140:143], v215 offset:2624
v_mfma_f32_16x16x32_bf16 v[20:23], v[48:51], v[104:107], v[20:23]
v_mfma_f32_16x16x32_bf16 v[24:27], v[48:51], v[108:111], v[24:27]
ds_read_b128 v[80:83], v241 offset:1600
ds_read_b64_tr_b16 a[8:9], v204 offset:2048
ds_read_b64_tr_b16 a[10:11], v204 offset:3072
ds_read_b64_tr_b16 a[12:13], v205 offset:2048
ds_read_b64_tr_b16 a[14:15], v205 offset:3072
v_mfma_f32_16x16x32_bf16 v[28:31], v[48:51], v[112:115], 0
buffer_load_dwordx4 v217, s[52:55], s3 offen lds
v_mfma_f32_16x16x32_bf16 v[20:23], v[36:39], v[116:119], v[20:23]
ds_read_b128 v[144:147], v215 offset:2112
v_mfma_f32_16x16x32_bf16 v[24:27], v[40:43], v[116:119], v[24:27]
v_mfma_f32_16x16x32_bf16 v[28:31], v[44:47], v[116:119], v[28:31]
ds_read_b128 v[84:87], v241 offset:2112
v_mfma_f32_16x16x32_bf16 v[32:35], v[48:51], v[116:119], 0
s_add_u32 m0, s91, 0x5000
s_add_u32 s3, s94, 28672
buffer_load_dwordx4 v216, s[52:55], s3 offen lds
s_add_u32 m0, s91, 0x5400
v_mfma_f32_16x16x32_bf16 v[20:23], v[52:55], v[100:103], v[20:23]
ds_read_b128 v[148:151], v215 offset:1600
v_mfma_f32_16x16x32_bf16 v[24:27], v[52:55], v[104:107], v[24:27]
v_mfma_f32_16x16x32_bf16 v[28:31], v[52:55], v[108:111], v[28:31]
ds_read_b128 v[88:91], v241 offset:2624
v_mfma_f32_16x16x32_bf16 v[32:35], v[52:55], v[112:115], v[32:35]
buffer_load_dwordx4 v217, s[52:55], s3 offen lds
v_mfma_f32_16x16x32_bf16 v[24:27], v[36:39], v[120:123], v[24:27]
ds_read_b128 v[152:155], v215 offset:1088
ds_read_b64_tr_b16 a[16:17], v204 offset:4096
ds_read_b64_tr_b16 a[18:19], v204 offset:5120
ds_read_b64_tr_b16 a[20:21], v205 offset:4096
ds_read_b64_tr_b16 a[22:23], v205 offset:5120
v_mfma_f32_16x16x32_bf16 v[28:31], v[40:43], v[120:123], v[28:31]
v_mfma_f32_16x16x32_bf16 v[32:35], v[44:47], v[120:123], v[32:35]
ds_read_b128 v[92:95], v241 offset:3136
v_mfma_f32_16x16x32_bf16 v[24:27], v[56:59], v[100:103], v[24:27]
buffer_load_dwordx4 v[164:167], v252, s[32:35], 0 offen offset:0
v_mfma_f32_16x16x32_bf16 v[28:31], v[56:59], v[104:107], v[28:31]
ds_read_b128 v[156:159], v215 offset:576
v_mfma_f32_16x16x32_bf16 v[32:35], v[56:59], v[108:111], v[32:35]
v_mfma_f32_16x16x32_bf16 v[28:31], v[36:39], v[124:127], v[28:31]
ds_read_b128 v[96:99], v241 offset:3648
s_waitcnt vmcnt(7)
s_lshl_b32 s78, s75, 1
s_add_u32 s78, s78, s87
s_lshl_b32 s78, s78, 4
s_add_u32 s78, s78, s76
s_lshl_b32 s78, s78, 1
s_add_u32 s78, s78, s86
s_lshl_b32 s78, s78, 2
s_add_u32 s78, s78, 16384
v_mov_b32 v255, s78
v_mov_b32 v254, s77
s_mov_b64 exec, 1
buffer_store_dword v254, v255, s[60:63], 0 offen sc1
s_mov_b64 exec, -1
v_mfma_f32_16x16x32_bf16 v[32:35], v[40:43], v[124:127], v[32:35]
buffer_load_dwordx4 v[168:171], v252, s[32:35], 0 offen offset:32
v_mfma_f32_16x16x32_bf16 v[28:31], v[60:63], v[100:103], v[28:31]
ds_read_b128 v[160:163], v215 offset:64
v_mfma_f32_16x16x32_bf16 v[32:35], v[60:63], v[104:107], v[32:35]
v_mfma_f32_16x16x32_bf16 v[32:35], v[36:39], v[128:131], v[32:35]
ds_read_b64_tr_b16 a[24:25], v204 offset:6144
ds_read_b64_tr_b16 a[26:27], v204 offset:7168
ds_read_b64_tr_b16 a[28:29], v205 offset:6144
ds_read_b64_tr_b16 a[30:31], v205 offset:7168
v_mfma_f32_16x16x32_bf16 v[32:35], v[64:67], v[100:103], v[32:35]
s_add_u32 m0, s91, 0x0
s_add_u32 s3, s94, 43008
buffer_load_dwordx4 v216, s[52:55], s3 offen lds
s_add_u32 m0, s91, 0x400
v_mfma_f32_16x16x32_bf16 v[4:7], v[68:71], v[132:135], v[4:7]
v_mfma_f32_16x16x32_bf16 v[8:11], v[68:71], v[136:139], v[8:11]
v_mfma_f32_16x16x32_bf16 v[8:11], v[72:75], v[132:135], v[8:11]
ds_read_b128 v[36:39], v241 offset:128
v_mfma_f32_16x16x32_bf16 v[12:15], v[72:75], v[136:139], v[12:15]
buffer_load_dwordx4 v217, s[52:55], s3 offen lds
v_mfma_f32_16x16x32_bf16 v[12:15], v[68:71], v[140:143], v[12:15]
ds_read_b128 v[100:103], v215 offset:3712
v_mfma_f32_16x16x32_bf16 v[16:19], v[72:75], v[140:143], v[16:19]
v_mfma_f32_16x16x32_bf16 v[12:15], v[76:79], v[132:135], v[12:15]
ds_read_b128 v[40:43], v241 offset:640
v_mfma_f32_16x16x32_bf16 v[16:19], v[76:79], v[136:139], v[16:19]
s_add_u32 s94, s94, 57344
s_cmp_eq_u32 s94, 401408
s_cselect_b32 s94, 0, s94
s_add_u32 m0, s91, 0x800
s_add_u32 s3, s94, 0
buffer_load_dwordx4 v216, s[52:55], s3 offen lds
s_add_u32 m0, s91, 0xc00
v_mfma_f32_16x16x32_bf16 v[20:23], v[76:79], v[140:143], v[20:23]
ds_read_b128 v[104:107], v215 offset:3200
ds_read_b64_tr_b16 a[32:33], v204 offset:8192
ds_read_b64_tr_b16 a[34:35], v204 offset:9216
ds_read_b64_tr_b16 a[36:37], v205 offset:8192
ds_read_b64_tr_b16 a[38:39], v205 offset:9216
v_mfma_f32_16x16x32_bf16 v[16:19], v[68:71], v[144:147], v[16:19]
v_mfma_f32_16x16x32_bf16 v[20:23], v[72:75], v[144:147], v[20:23]
ds_read_b128 v[44:47], v241 offset:1152
v_mfma_f32_16x16x32_bf16 v[24:27], v[76:79], v[144:147], v[24:27]
buffer_load_dwordx4 v217, s[52:55], s3 offen lds
v_mfma_f32_16x16x32_bf16 v[16:19], v[80:83], v[132:135], v[16:19]
ds_read_b128 v[108:111], v215 offset:2688
v_mfma_f32_16x16x32_bf16 v[20:23], v[80:83], v[136:139], v[20:23]
v_mfma_f32_16x16x32_bf16 v[24:27], v[80:83], v[140:143], v[24:27]
ds_read_b128 v[48:51], v241 offset:1664
v_mfma_f32_16x16x32_bf16 v[28:31], v[80:83], v[144:147], v[28:31]
s_add_u32 m0, s91, 0x1000
s_add_u32 s3, s94, 14336
buffer_load_dwordx4 v216, s[52:55], s3 offen lds
s_add_u32 m0, s91, 0x1400
v_mfma_f32_16x16x32_bf16 v[20:23], v[68:71], v[148:151], v[20:23]
ds_read_b128 v[112:115], v215 offset:2176
v_mfma_f32_16x16x32_bf16 v[24:27], v[72:75], v[148:151], v[24:27]
v_mfma_f32_16x16x32_bf16 v[28:31], v[76:79], v[148:151], v[28:31]
ds_read_b128 v[52:55], v241 offset:2176
ds_read_b64_tr_b16 a[40:41], v204 offset:10240
ds_read_b64_tr_b16 a[42:43], v204 offset:11264
ds_read_b64_tr_b16 a[44:45], v205 offset:10240
ds_read_b64_tr_b16 a[46:47], v205 offset:11264
v_mfma_f32_16x16x32_bf16 v[32:35], v[80:83], v[148:151], v[32:35]
buffer_load_dwordx4 v217, s[52:55], s3 offen lds
v_mfma_f32_16x16x32_bf16 v[20:23], v[84:87], v[132:135], v[20:23]
ds_read_b128 v[116:119], v215 offset:1664
v_mfma_f32_16x16x32_bf16 v[24:27], v[84:87], v[136:139], v[24:27]
v_mfma_f32_16x16x32_bf16 v[28:31], v[84:87], v[140:143], v[28:31]
ds_read_b128 v[56:59], v241 offset:2688
v_mfma_f32_16x16x32_bf16 v[32:35], v[84:87], v[144:147], v[32:35]
s_add_u32 m0, s91, 0x1800
s_add_u32 s3, s94, 28672
buffer_load_dwordx4 v216, s[52:55], s3 offen lds
s_add_u32 m0, s91, 0x1c00
v_mfma_f32_16x16x32_bf16 v[24:27], v[68:71], v[152:155], v[24:27]
ds_read_b128 v[120:123], v215 offset:1152
v_mfma_f32_16x16x32_bf16 v[28:31], v[72:75], v[152:155], v[28:31]
v_mfma_f32_16x16x32_bf16 v[32:35], v[76:79], v[152:155], v[32:35]
ds_read_b128 v[60:63], v241 offset:3200
v_mfma_f32_16x16x32_bf16 v[24:27], v[88:91], v[132:135], v[24:27]
buffer_load_dwordx4 v217, s[52:55], s3 offen lds
v_mfma_f32_16x16x32_bf16 v[28:31], v[88:91], v[136:139], v[28:31]
ds_read_b128 v[124:127], v215 offset:640
ds_read_b64_tr_b16 a[48:49], v204 offset:12288
ds_read_b64_tr_b16 a[50:51], v204 offset:13312
ds_read_b64_tr_b16 a[52:53], v205 offset:12288
ds_read_b64_tr_b16 a[54:55], v205 offset:13312
v_mfma_f32_16x16x32_bf16 v[32:35], v[88:91], v[140:143], v[32:35]
v_mfma_f32_16x16x32_bf16 v[28:31], v[68:71], v[156:159], v[28:31]
ds_read_b128 v[64:67], v241 offset:3712
v_mfma_f32_16x16x32_bf16 v[32:35], v[72:75], v[156:159], v[32:35]
s_add_u32 m0, s91, 0x2000
s_add_u32 s3, s94, 43008
buffer_load_dwordx4 v216, s[52:55], s3 offen lds
s_add_u32 m0, s91, 0x2400
v_mfma_f32_16x16x32_bf16 v[28:31], v[92:95], v[132:135], v[28:31]
ds_read_b128 v[128:131], v215 offset:128
v_mfma_f32_16x16x32_bf16 v[32:35], v[92:95], v[136:139], v[32:35]
v_mfma_f32_16x16x32_bf16 v[32:35], v[68:71], v[160:163], v[32:35]
v_mfma_f32_16x16x32_bf16 v[32:35], v[96:99], v[132:135], v[32:35]
buffer_load_dwordx4 v217, s[52:55], s3 offen lds
v_mfma_f32_16x16x32_bf16 v[4:7], v[36:39], v[100:103], v[4:7]
v_mfma_f32_16x16x32_bf16 v[8:11], v[36:39], v[104:107], v[8:11]
v_mfma_f32_16x16x32_bf16 v[8:11], v[40:43], v[100:103], v[8:11]
ds_read_b128 v[68:71], v241 offset:192
ds_read_b64_tr_b16 a[56:57], v204 offset:14336
ds_read_b64_tr_b16 a[58:59], v204 offset:15360
ds_read_b64_tr_b16 a[60:61], v205 offset:14336
ds_read_b64_tr_b16 a[62:63], v205 offset:15360
v_mfma_f32_16x16x32_bf16 v[12:15], v[40:43], v[104:107], v[12:15]
s_add_u32 s94, s94, 57344
s_cmp_eq_u32 s94, 401408
s_cselect_b32 s94, 0, s94
s_add_u32 m0, s91, 0x2800
s_add_u32 s3, s94, 0
buffer_load_dwordx4 v216, s[52:55], s3 offen lds
s_add_u32 m0, s91, 0x2c00
v_mfma_f32_16x16x32_bf16 v[12:15], v[36:39], v[108:111], v[12:15]
ds_read_b128 v[132:135], v215 offset:3776
v_mfma_f32_16x16x32_bf16 v[16:19], v[40:43], v[108:111], v[16:19]
v_mfma_f32_16x16x32_bf16 v[12:15], v[44:47], v[100:103], v[12:15]
ds_read_b128 v[72:75], v241 offset:704
v_mfma_f32_16x16x32_bf16 v[16:19], v[44:47], v[104:107], v[16:19]
buffer_load_dwordx4 v217, s[52:55], s3 offen lds
v_mfma_f32_16x16x32_bf16 v[20:23], v[44:47], v[108:111], v[20:23]
ds_read_b128 v[136:139], v215 offset:3264
v_mfma_f32_16x16x32_bf16 v[16:19], v[36:39], v[112:115], v[16:19]
v_mfma_f32_16x16x32_bf16 v[20:23], v[40:43], v[112:115], v[20:23]
ds_read_b128 v[76:79], v241 offset:1216
v_mfma_f32_16x16x32_bf16 v[24:27], v[44:47], v[112:115], v[24:27]
s_waitcnt lgkmcnt(11)
s_add_u32 m0, s91, 0x3000
s_add_u32 s3, s94, 14336
buffer_load_dwordx4 v216, s[52:55], s3 offen lds
s_add_u32 m0, s91, 0x3400
v_mfma_f32_16x16x32_bf16 v[16:19], v[48:51], v[100:103], v[16:19]
ds_read_b128 v[140:143], v215 offset:2752
s_waitcnt vmcnt(20)
ds_read_b64_tr_b16 a[64:65], v204 offset:16384
ds_read_b64_tr_b16 a[66:67], v204 offset:17408
ds_read_b64_tr_b16 a[68:69], v205 offset:16384
ds_read_b64_tr_b16 a[70:71], v205 offset:17408
v_mfma_f32_16x16x32_bf16 v[20:23], v[48:51], v[104:107], v[20:23]
v_mfma_f32_16x16x32_bf16 v[24:27], v[48:51], v[108:111], v[24:27]
ds_read_b128 v[80:83], v241 offset:1728
v_mfma_f32_16x16x32_bf16 v[28:31], v[48:51], v[112:115], v[28:31]
buffer_load_dwordx4 v217, s[52:55], s3 offen lds
v_mfma_f32_16x16x32_bf16 v[20:23], v[36:39], v[116:119], v[20:23]
ds_read_b128 v[144:147], v215 offset:2240
v_mfma_f32_16x16x32_bf16 v[24:27], v[40:43], v[116:119], v[24:27]
v_mfma_f32_16x16x32_bf16 v[28:31], v[44:47], v[116:119], v[28:31]
ds_read_b128 v[84:87], v241 offset:2240
v_mfma_f32_16x16x32_bf16 v[32:35], v[48:51], v[116:119], v[32:35]
s_waitcnt lgkmcnt(12)
s_add_u32 m0, s91, 0x3800
s_add_u32 s3, s94, 28672
buffer_load_dwordx4 v216, s[52:55], s3 offen lds
s_add_u32 m0, s91, 0x3c00
v_mfma_f32_16x16x32_bf16 v[20:23], v[52:55], v[100:103], v[20:23]
ds_read_b128 v[148:151], v215 offset:1728
v_mfma_f32_16x16x32_bf16 v[24:27], v[52:55], v[104:107], v[24:27]
v_mfma_f32_16x16x32_bf16 v[28:31], v[52:55], v[108:111], v[28:31]
ds_read_b128 v[88:91], v241 offset:2752
s_waitcnt vmcnt(20)
ds_read_b64_tr_b16 a[72:73], v204 offset:18432
ds_read_b64_tr_b16 a[74:75], v204 offset:19456
ds_read_b64_tr_b16 a[76:77], v205 offset:18432
ds_read_b64_tr_b16 a[78:79], v205 offset:19456
v_mfma_f32_16x16x32_bf16 v[32:35], v[52:55], v[112:115], v[32:35]
buffer_load_dwordx4 v217, s[52:55], s3 offen lds
v_mfma_f32_16x16x32_bf16 v[24:27], v[36:39], v[120:123], v[24:27]
ds_read_b128 v[152:155], v215 offset:1216
v_mfma_f32_16x16x32_bf16 v[28:31], v[40:43], v[120:123], v[28:31]
v_mfma_f32_16x16x32_bf16 v[32:35], v[44:47], v[120:123], v[32:35]
ds_read_b128 v[92:95], v241 offset:3264
v_mfma_f32_16x16x32_bf16 v[24:27], v[56:59], v[100:103], v[24:27]
s_waitcnt lgkmcnt(11)
s_add_u32 m0, s91, 0x4000
s_add_u32 s3, s94, 43008
buffer_load_dwordx4 v216, s[52:55], s3 offen lds
s_add_u32 m0, s91, 0x4400
v_mfma_f32_16x16x32_bf16 v[28:31], v[56:59], v[104:107], v[28:31]
ds_read_b128 v[156:159], v215 offset:704
buffer_load_dword v197, v198, s[60:63], 0 offen sc1
v_mfma_f32_16x16x32_bf16 v[32:35], v[56:59], v[108:111], v[32:35]
v_mfma_f32_16x16x32_bf16 v[28:31], v[36:39], v[124:127], v[28:31]
ds_read_b128 v[96:99], v241 offset:3776
v_mfma_f32_16x16x32_bf16 v[32:35], v[40:43], v[124:127], v[32:35]
buffer_load_dwordx4 v217, s[52:55], s3 offen lds
v_mfma_f32_16x16x32_bf16 v[28:31], v[60:63], v[100:103], v[28:31]
ds_read_b128 v[160:163], v215 offset:192
s_waitcnt vmcnt(22)
ds_read_b64_tr_b16 a[80:81], v204 offset:20480
ds_read_b64_tr_b16 a[82:83], v204 offset:21504
ds_read_b64_tr_b16 a[84:85], v205 offset:20480
ds_read_b64_tr_b16 a[86:87], v205 offset:21504
v_mfma_f32_16x16x32_bf16 v[32:35], v[60:63], v[104:107], v[32:35]
v_mfma_f32_16x16x32_bf16 v[32:35], v[36:39], v[128:131], v[32:35]
v_mfma_f32_16x16x32_bf16 v[32:35], v[64:67], v[100:103], v[32:35]
s_waitcnt lgkmcnt(9)
s_add_u32 s94, s94, 57344
s_cmp_eq_u32 s94, 401408
s_cselect_b32 s94, 0, s94
s_add_u32 m0, s91, 0x4800
s_add_u32 s3, s94, 0
buffer_load_dwordx4 v216, s[52:55], s3 offen lds
s_add_u32 m0, s91, 0x4c00
v_mfma_f32_16x16x32_bf16 v[4:7], v[68:71], v[132:135], v[4:7]
v_mfma_f32_16x16x32_bf16 v[8:11], v[68:71], v[136:139], v[8:11]
v_mfma_f32_16x16x32_bf16 v[8:11], v[72:75], v[132:135], v[8:11]
v_mfma_f32_16x16x32_bf16 v[12:15], v[72:75], v[136:139], v[12:15]
buffer_load_dwordx4 v217, s[52:55], s3 offen lds
v_mfma_f32_16x16x32_bf16 v[12:15], v[68:71], v[140:143], v[12:15]
v_mfma_f32_16x16x32_bf16 v[16:19], v[72:75], v[140:143], v[16:19]
v_mfma_f32_16x16x32_bf16 v[12:15], v[76:79], v[132:135], v[12:15]
s_waitcnt vmcnt(19)
ds_read_b64_tr_b16 a[88:89], v204 offset:0
ds_read_b64_tr_b16 a[90:91], v204 offset:1024
ds_read_b64_tr_b16 a[92:93], v205 offset:0
ds_read_b64_tr_b16 a[94:95], v205 offset:1024
v_mfma_f32_16x16x32_bf16 v[16:19], v[76:79], v[136:139], v[16:19]
s_waitcnt lgkmcnt(4)
s_add_u32 m0, s91, 0x5000
s_add_u32 s3, s94, 14336
buffer_load_dwordx4 v216, s[52:55], s3 offen lds
s_add_u32 m0, s91, 0x5400
v_mfma_f32_16x16x32_bf16 v[20:23], v[76:79], v[140:143], v[20:23]
v_mfma_f32_16x16x32_bf16 v[16:19], v[68:71], v[144:147], v[16:19]
v_mfma_f32_16x16x32_bf16 v[20:23], v[72:75], v[144:147], v[20:23]
s_waitcnt vmcnt(4)
v_cmp_ne_u32 vcc, s77, v197
s_cbranch_vccz L_flagok_5
s_mov_b32 s98, 131072
L_flagpoll_6:
buffer_load_dword v197, v198, s[60:63], 0 offen sc1
s_waitcnt vmcnt(0)
v_cmp_ne_u32 vcc, s77, v197
s_cbranch_vccz L_flagok_5
s_sub_u32 s98, s98, 1
s_cbranch_scc0 L_flagpoll_6
L_flagok_5:
v_lshlrev_b32 v255, 4, v246
v_add_u32 v255, 458752, v255
buffer_load_dwordx4 v[232:235], v255, s[60:63], 0 offen sc1
v_mfma_f32_16x16x32_bf16 v[24:27], v[76:79], v[144:147], v[24:27]
buffer_load_dwordx4 v217, s[52:55], s3 offen lds
v_mfma_f32_16x16x32_bf16 v[16:19], v[80:83], v[132:135], v[16:19]
v_mfma_f32_16x16x32_bf16 v[20:23], v[80:83], v[136:139], v[20:23]
v_mfma_f32_16x16x32_bf16 v[24:27], v[80:83], v[140:143], v[24:27]
v_mfma_f32_16x16x32_bf16 v[28:31], v[80:83], v[144:147], v[28:31]
s_lshl_b32 s93, s99, 12
s_add_u32 s36, s40, s93
s_add_u32 s37, s41, s93
buffer_load_dwordx4 a[112:115], v237, s[60:63], s36 offen offset:0 sc1
v_mfma_f32_16x16x32_bf16 v[20:23], v[68:71], v[148:151], v[20:23]
ds_read_b64_tr_b16 a[96:97], v204 offset:2048
ds_read_b64_tr_b16 a[98:99], v204 offset:3072
ds_read_b64_tr_b16 a[100:101], v205 offset:2048
ds_read_b64_tr_b16 a[102:103], v205 offset:3072
v_mfma_f32_16x16x32_bf16 v[24:27], v[72:75], v[148:151], v[24:27]
v_mfma_f32_16x16x32_bf16 v[28:31], v[76:79], v[148:151], v[28:31]
v_mfma_f32_16x16x32_bf16 v[32:35], v[80:83], v[148:151], v[32:35]
buffer_load_dwordx4 a[116:119], v237, s[60:63], s37 offen offset:0 sc1
v_mfma_f32_16x16x32_bf16 v[20:23], v[84:87], v[132:135], v[20:23]
v_mfma_f32_16x16x32_bf16 v[24:27], v[84:87], v[136:139], v[24:27]
v_mfma_f32_16x16x32_bf16 v[28:31], v[84:87], v[140:143], v[28:31]
v_mfma_f32_16x16x32_bf16 v[32:35], v[84:87], v[144:147], v[32:35]
buffer_load_dwordx4 a[120:123], v237, s[60:63], s36 offen offset:1024 sc1
v_mfma_f32_16x16x32_bf16 v[24:27], v[68:71], v[152:155], v[24:27]
v_mfma_f32_16x16x32_bf16 v[28:31], v[72:75], v[152:155], v[28:31]
v_mfma_f32_16x16x32_bf16 v[32:35], v[76:79], v[152:155], v[32:35]
ds_read_b64_tr_b16 a[104:105], v204 offset:4096
ds_read_b64_tr_b16 a[106:107], v204 offset:5120
ds_read_b64_tr_b16 a[108:109], v205 offset:4096
ds_read_b64_tr_b16 a[110:111], v205 offset:5120
v_mfma_f32_16x16x32_bf16 v[24:27], v[88:91], v[132:135], v[24:27]
buffer_load_dwordx4 a[124:127], v237, s[60:63], s37 offen offset:1024 sc1
v_mfma_f32_16x16x32_bf16 v[28:31], v[88:91], v[136:139], v[28:31]
v_mfma_f32_16x16x32_bf16 v[32:35], v[88:91], v[140:143], v[32:35]
v_mfma_f32_16x16x32_bf16 v[28:31], v[68:71], v[156:159], v[28:31]
v_mfma_f32_16x16x32_bf16 v[32:35], v[72:75], v[156:159], v[32:35]
buffer_load_dwordx4 a[128:131], v237, s[60:63], s36 offen offset:2048 sc1
v_mfma_f32_16x16x32_bf16 v[28:31], v[92:95], v[132:135], v[28:31]
v_mfma_f32_16x16x32_bf16 v[32:35], v[92:95], v[136:139], v[32:35]
v_mfma_f32_16x16x32_bf16 v[32:35], v[68:71], v[160:163], v[32:35]
v_mfma_f32_16x16x32_bf16 v[32:35], v[96:99], v[132:135], v[32:35]
buffer_load_dwordx4 a[132:135], v237, s[60:63], s37 offen offset:2048 sc1
ds_read_b128 v[36:39], v214 offset:1536
ds_read_b128 v[40:43], v214 offset:1024
ds_read_b128 v[44:47], v214 offset:512
ds_read_b128 v[48:51], v214 offset:0
s_mul_i32 s78, s88, 61952
s_add_u32 s78, s78, 90112
s_lshl_b32 s79, s89, 12
s_add_u32 s80, s78, s79
v_add_u32 v255, s80, v237
s_xor_b32 s79, s79, 4096
s_add_u32 s80, s78, s79
v_add_u32 v253, s80, v237
s_nop 7
s_cmp_eq_u32 s89, 0
s_cbranch_scc0 L_hf1_7
ds_write_b128 v255, v[20:23] offset:0
ds_write_b128 v255, v[24:27] offset:1024
ds_write_b128 v255, v[28:31] offset:2048
ds_write_b128 v255, v[32:35] offset:3072
s_branch L_hfj_8
L_hf1_7:
ds_write_b128 v255, v[4:7] offset:0
ds_write_b128 v255, v[8:11] offset:1024
ds_write_b128 v255, v[12:15] offset:2048
ds_write_b128 v255, v[16:19] offset:3072
v_mov_b32 v4, v20
v_mov_b32 v5, v21
v_mov_b32 v6, v22
v_mov_b32 v7, v23
v_mov_b32 v8, v24
v_mov_b32 v9, v25
v_mov_b32 v10, v26
v_mov_b32 v11, v27
v_mov_b32 v12, v28
v_mov_b32 v13, v29
v_mov_b32 v14, v30
v_mov_b32 v15, v31
v_mov_b32 v16, v32
v_mov_b32 v17, v33
v_mov_b32 v18, v34
v_mov_b32 v19, v35
L_hfj_8:
s_waitcnt lgkmcnt(4)
v_lshlrev_b32 v36, 16, v36
v_lshlrev_b32 v37, 16, v37
v_lshlrev_b32 v38, 16, v38
v_lshlrev_b32 v39, 16, v39
buffer_load_dwordx4 a[136:139], v237, s[60:63], s36 offen offset:3072 sc1
v_lshlrev_b32 v40, 16, v40
v_lshlrev_b32 v41, 16, v41
v_lshlrev_b32 v42, 16, v42
v_lshlrev_b32 v43, 16, v43
buffer_load_dwordx4 a[140:143], v237, s[60:63], s37 offen offset:3072 sc1
v_lshlrev_b32 v44, 16, v44
v_lshlrev_b32 v45, 16, v45
v_lshlrev_b32 v46, 16, v46
v_lshlrev_b32 v47, 16, v47
s_add_u32 s93, s93, 4096
s_cmp_eq_u32 s93, 28672
s_cselect_b32 s93, 0, s93
s_add_u32 s36, s40, s93
s_add_u32 s37, s41, s93
buffer_load_dwordx4 a[144:147], v237, s[60:63], s36 offen offset:0 sc1
v_lshlrev_b32 v48, 16, v48
v_lshlrev_b32 v49, 16, v49
v_lshlrev_b32 v50, 16, v50
v_lshlrev_b32 v51, 16, v51
buffer_load_dwordx4 a[148:151], v237, s[60:63], s37 offen offset:0 sc1
v_fmac_f32 v4, v188, v39
v_fmac_f32 v5, v188, v38
v_fmac_f32 v6, v188, v37
v_fmac_f32 v7, v188, v36
buffer_load_dwordx4 a[152:155], v237, s[60:63], s36 offen offset:1024 sc1
v_fmac_f32 v8, v188, v43
v_fmac_f32 v9, v188, v42
v_fmac_f32 v10, v188, v41
v_fmac_f32 v11, v188, v40
buffer_load_dwordx4 a[156:159], v237, s[60:63], s37 offen offset:1024 sc1
v_fmac_f32 v12, v188, v47
v_fmac_f32 v13, v188, v46
v_fmac_f32 v14, v188, v45
v_fmac_f32 v15, v188, v44
buffer_load_dwordx4 a[160:163], v237, s[60:63], s36 offen offset:2048 sc1
v_fmac_f32 v16, v188, v51
v_fmac_f32 v17, v188, v50
v_fmac_f32 v18, v188, v49
v_fmac_f32 v19, v188, v48
buffer_load_dwordx4 a[164:167], v237, s[60:63], s37 offen offset:2048 sc1
s_waitcnt lgkmcnt(0)
s_barrier
ds_read_b128 v[52:55], v253 offset:0
ds_read_b128 v[56:59], v253 offset:1024
ds_read_b128 v[60:63], v253 offset:2048
ds_read_b128 v[64:67], v253 offset:3072
buffer_load_dwordx4 a[168:171], v237, s[60:63], s36 offen offset:3072 sc1
s_waitcnt lgkmcnt(3)
v_pk_add_f32 v[4:5], v[4:5], v[52:53]
v_pk_add_f32 v[6:7], v[6:7], v[54:55]
v_cvt_pk_bf16_f32 v228, v4, v5
v_cvt_pk_bf16_f32 v229, v6, v7
v_cndmask_b32 v230, v229, v228, s[96:97]
v_cndmask_b32 v231, v228, v229, s[96:97]
s_nop 0
v_mov_b32_dpp v228, v230 quad_perm:[1,0,3,2] row_mask:0xf bank_mask:0xf
v_perm_b32 v68, v228, v231, v206
v_perm_b32 v69, v228, v231, v207
buffer_store_dwordx2 v[68:69], v213, s[60:63], 0 offen offset:0 sc1
buffer_load_dwordx4 a[172:175], v237, s[60:63], s37 offen offset:3072 sc1
s_waitcnt lgkmcnt(2)
v_pk_add_f32 v[8:9], v[8:9], v[56:57]
v_pk_add_f32 v[10:11], v[10:11], v[58:59]
v_cvt_pk_bf16_f32 v228, v8, v9
v_cvt_pk_bf16_f32 v229, v10, v11
v_cndmask_b32 v230, v229, v228, s[96:97]
v_cndmask_b32 v231, v228, v229, s[96:97]
s_nop 0
v_mov_b32_dpp v228, v230 quad_perm:[1,0,3,2] row_mask:0xf bank_mask:0xf
v_perm_b32 v70, v228, v231, v206
v_perm_b32 v71, v228, v231, v207
buffer_store_dwordx2 v[70:71], v213, s[60:63], 0 offen offset:512 sc1
s_add_u32 m0, s91, 0x0
s_add_u32 s3, s94, 28672
buffer_load_dwordx4 v216, s[52:55], s3 offen lds
s_add_u32 m0, s91, 0x400
s_waitcnt lgkmcnt(1)
v_pk_add_f32 v[12:13], v[12:13], v[60:61]
v_pk_add_f32 v[14:15], v[14:15], v[62:63]
v_cvt_pk_bf16_f32 v228, v12, v13
v_cvt_pk_bf16_f32 v229, v14, v15
v_cndmask_b32 v230, v229, v228, s[96:97]
v_cndmask_b32 v231, v228, v229, s[96:97]
s_nop 0
v_mov_b32_dpp v228, v230 quad_perm:[1,0,3,2] row_mask:0xf bank_mask:0xf
v_perm_b32 v72, v228, v231, v206
v_perm_b32 v73, v228, v231, v207
buffer_store_dwordx2 v[72:73], v213, s[60:63], 0 offen offset:1024 sc1
buffer_load_dwordx4 v217, s[52:55], s3 offen lds
s_waitcnt lgkmcnt(0)
v_pk_add_f32 v[16:17], v[16:17], v[64:65]
v_pk_add_f32 v[18:19], v[18:19], v[66:67]
v_cvt_pk_bf16_f32 v228, v16, v17
v_cvt_pk_bf16_f32 v229, v18, v19
v_cndmask_b32 v230, v229, v228, s[96:97]
v_cndmask_b32 v231, v228, v229, s[96:97]
s_nop 0
v_mov_b32_dpp v228, v230 quad_perm:[1,0,3,2] row_mask:0xf bank_mask:0xf
v_perm_b32 v74, v228, v231, v206
v_perm_b32 v75, v228, v231, v207
buffer_store_dwordx2 v[74:75], v213, s[60:63], 0 offen offset:1536 sc1
s_add_u32 s93, s93, 4096
s_cmp_eq_u32 s93, 28672
s_cselect_b32 s93, 0, s93
s_add_u32 s36, s40, s93
s_add_u32 s37, s41, s93
buffer_load_dwordx4 a[176:179], v237, s[60:63], s36 offen offset:0 sc1
s_mov_b32 s56, s24
s_mov_b32 s57, s25
s_mov_b32 s58, 0x1c0000
s_mov_b32 s59, 0x00020000
s_waitcnt vmcnt(21)
v_mfma_f32_32x32x16_bf16 v[4:19], a[0:3], a[112:115], 0
s_lshl_b32 s0, s72, 6
v_mfma_f32_32x32x16_bf16 v[20:35], a[0:3], a[116:119], 0
buffer_load_dwordx4 a[180:183], v237, s[60:63], s37 offen offset:0 sc1
s_lshl_b32 s1, s42, 5
s_add_u32 s0, s0, s1
v_mfma_f32_32x32x16_bf16 v[36:51], a[4:7], a[112:115], 0
v_add_u32 v244, s0, v238
s_lshr_b32 s1, s74, 4
s_lshl_b32 s1, s1, 9
v_mfma_f32_32x32x16_bf16 v[52:67], a[4:7], a[116:119], 0
buffer_load_dwordx4 a[184:187], v237, s[60:63], s36 offen offset:1024 sc1
v_add_u32 v244, s1, v244
v_lshlrev_b32 v244, 2, v244
v_add_u32 v198, 24576, v244
s_waitcnt vmcnt(21)
v_mfma_f32_32x32x16_bf16 v[4:19], a[8:11], a[120:123], v[4:19]
s_lshl_b32 s1, s74, 1
v_mfma_f32_32x32x16_bf16 v[20:35], a[8:11], a[124:127], v[20:35]
buffer_load_dwordx4 a[188:191], v237, s[60:63], s37 offen offset:1024 sc1
s_add_u32 s1, s1, s43
s_lshl_b32 s100, s1, 5
v_mfma_f32_32x32x16_bf16 v[36:51], a[12:15], a[120:123], v[36:51]
v_add_u32 v246, s100, v238
s_lshl_b32 s1, s0, 1
v_mul_u32_u24 v245, 896, v246
v_mfma_f32_32x32x16_bf16 v[52:67], a[12:15], a[124:127], v[52:67]
buffer_load_dwordx4 a[192:195], v237, s[60:63], s36 offen offset:2048 sc1
v_add_u32 v245, s1, v245
s_lshl_b32 s100, s43, 4
s_add_u32 s0, s0, s100
s_waitcnt vmcnt(21)
v_mfma_f32_32x32x16_bf16 v[4:19], a[16:19], a[128:131], v[4:19]
s_lshl_b32 s0, s0, 12
v_mfma_f32_32x32x16_bf16 v[20:35], a[16:19], a[132:135], v[20:35]
buffer_load_dwordx4 a[196:199], v237, s[60:63], s37 offen offset:2048 sc1
s_lshl_b32 s100, s74, 7
s_add_u32 s0, s0, s100
v_mfma_f32_32x32x16_bf16 v[36:51], a[20:23], a[128:131], v[36:51]
s_add_u32 s0, s0, 2363392
v_lshlrev_b32 v244, 12, v251
v_lshl_add_u32 v244, v250, 4, v244
v_mfma_f32_32x32x16_bf16 v[52:67], a[20:23], a[132:135], v[52:67]
buffer_load_dwordx4 a[200:203], v237, s[60:63], s36 offen offset:3072 sc1
v_add_u32 v242, s0, v244
v_add_u32 v243, 0x8000, v242
v_lshl_add_u32 v244, v239, 3, v245
s_waitcnt vmcnt(21)
v_mfma_f32_32x32x16_bf16 v[4:19], a[24:27], a[136:139], v[4:19]
v_lshlrev_b32 v241, 3, v246
v_mfma_f32_32x32x16_bf16 v[20:35], a[24:27], a[140:143], v[20:35]
buffer_load_dwordx4 a[204:207], v237, s[60:63], s37 offen offset:3072 sc1
v_add_u32 v241, 458752, v241
v_mfma_f32_32x32x16_bf16 v[36:51], a[28:31], a[136:139], v[36:51]
v_mfma_f32_32x32x16_bf16 v[52:67], a[28:31], a[140:143], v[52:67]
s_add_u32 s93, s93, 4096
s_cmp_eq_u32 s93, 28672
s_cselect_b32 s93, 0, s93
s_add_u32 s36, s40, s93
s_add_u32 s37, s41, s93
buffer_load_dwordx4 a[208:211], v237, s[60:63], s36 offen offset:0 sc1
s_waitcnt vmcnt(21)
v_mfma_f32_32x32x16_bf16 v[4:19], a[32:35], a[144:147], v[4:19]
v_mfma_f32_32x32x16_bf16 v[20:35], a[32:35], a[148:151], v[20:35]
buffer_load_dwordx4 a[212:215], v237, s[60:63], s37 offen offset:0 sc1
v_mfma_f32_32x32x16_bf16 v[36:51], a[36:39], a[144:147], v[36:51]
v_mfma_f32_32x32x16_bf16 v[52:67], a[36:39], a[148:151], v[52:67]
buffer_load_dwordx4 a[216:219], v237, s[60:63], s36 offen offset:1024 sc1
s_waitcnt vmcnt(21)
v_mfma_f32_32x32x16_bf16 v[4:19], a[40:43], a[152:155], v[4:19]
v_mfma_f32_32x32x16_bf16 v[20:35], a[40:43], a[156:159], v[20:35]
buffer_load_dwordx4 a[220:223], v237, s[60:63], s37 offen offset:1024 sc1
v_mfma_f32_32x32x16_bf16 v[36:51], a[44:47], a[152:155], v[36:51]
v_mfma_f32_32x32x16_bf16 v[52:67], a[44:47], a[156:159], v[52:67]
buffer_load_dwordx4 a[224:227], v237, s[60:63], s36 offen offset:2048 sc1
s_waitcnt vmcnt(21)
v_mfma_f32_32x32x16_bf16 v[4:19], a[48:51], a[160:163], v[4:19]
v_mfma_f32_32x32x16_bf16 v[20:35], a[48:51], a[164:167], v[20:35]
buffer_load_dwordx4 a[228:231], v237, s[60:63], s37 offen offset:2048 sc1
v_mfma_f32_32x32x16_bf16 v[36:51], a[52:55], a[160:163], v[36:51]
v_mfma_f32_32x32x16_bf16 v[52:67], a[52:55], a[164:167], v[52:67]
buffer_load_dwordx4 a[232:235], v237, s[60:63], s36 offen offset:3072 sc1
s_waitcnt vmcnt(20)
v_mfma_f32_32x32x16_bf16 v[4:19], a[56:59], a[168:171], v[4:19]
s_lshl_b32 s0, s42, 12
v_mfma_f32_32x32x16_bf16 v[20:35], a[56:59], a[172:175], v[20:35]
buffer_load_dwordx4 a[236:239], v237, s[60:63], s37 offen offset:3072 sc1
s_add_u32 s0, s0, 131584
s_lshl_b32 s1, s43, 11
v_mfma_f32_32x32x16_bf16 v[36:51], a[60:63], a[168:171], v[36:51]
s_add_u32 s1, s1, s0
v_bfe_u32 v228, v251, 1, 1
v_lshlrev_b32 v228, 2, v228
v_mfma_f32_32x32x16_bf16 v[52:67], a[60:63], a[172:175], v[52:67]
s_add_u32 s93, s93, 4096
s_cmp_eq_u32 s93, 28672
s_cselect_b32 s93, 0, s93
s_add_u32 s36, s40, s93
s_add_u32 s37, s41, s93
buffer_load_dwordx4 a[240:243], v237, s[60:63], s36 offen offset:0 sc1
v_xor_b32 v228, v228, v250
v_lshlrev_b32 v236, 7, v251
v_lshl_add_u32 v236, v228, 4, v236
s_waitcnt vmcnt(15)
v_mfma_f32_32x32x16_bf16 v[4:19], a[64:67], a[176:179], v[4:19]
v_add_u32 v236, s1, v236
v_mfma_f32_32x32x16_bf16 v[20:35], a[64:67], a[180:183], v[20:35]
buffer_load_dwordx4 a[244:247], v237, s[60:63], s37 offen offset:0 sc1
v_lshlrev_b32 v225, 2, v239
v_add_u32 v225, v225, v221
v_mfma_f32_32x32x16_bf16 v[36:51], a[68:71], a[176:179], v[36:51]
v_lshl_add_u32 v225, v225, 7, v218
v_lshrrev_b32 v228, 1, v221
v_xor_b32 v228, s43, v228
v_mfma_f32_32x32x16_bf16 v[52:67], a[68:71], a[180:183], v[52:67]
buffer_load_dwordx4 a[248:251], v237, s[60:63], s36 offen offset:1024 sc1
v_lshlrev_b32 v228, 2, v228
v_xor_b32 v228, v228, v219
v_lshl_add_u32 v225, v228, 4, v225
s_lshr_b32 s78, s16, 12
s_lshl_b32 s79, s89, 9
s_add_u32 s78, s78, s79
s_lshl_b32 s78, s78, 2
s_add_u32 s78, s78, 24576
v_mov_b32 v255, s78
v_mov_b32 v254, s77
s_mov_b64 exec, 1
buffer_store_dword v254, v255, s[60:63], 0 offen sc1
s_mov_b64 exec, -1
s_waitcnt vmcnt(16)
v_mfma_f32_32x32x16_bf16 v[4:19], a[72:75], a[184:187], v[4:19]
v_add_u32 v225, s0, v225
v_mfma_f32_32x32x16_bf16 v[20:35], a[72:75], a[188:191], v[20:35]
buffer_load_dwordx4 a[252:255], v237, s[60:63], s37 offen offset:1024 sc1
v_add_u32 v224, s91, v237
s_xor_b32 s0, s73, 1
v_mfma_f32_32x32x16_bf16 v[36:51], a[76:79], a[184:187], v[36:51]
s_mul_i32 s0, s0, 22528
v_add_u32 v212, s0, v237
s_xor_b32 s0, s73, 2
v_mfma_f32_32x32x16_bf16 v[52:67], a[76:79], a[188:191], v[52:67]
s_add_u32 m0, s91, 0x800
s_add_u32 s3, s94, 43008
buffer_load_dwordx4 v216, s[52:55], s3 offen lds
s_add_u32 m0, s91, 0xc00
s_mul_i32 s0, s0, 22528
v_add_u32 v213, s0, v237
s_xor_b32 s0, s73, 3
s_waitcnt vmcnt(16)
v_mfma_f32_32x32x16_bf16 v[4:19], a[80:83], a[192:195], v[4:19]
s_mul_i32 s0, s0, 22528
v_mfma_f32_32x32x16_bf16 v[20:35], a[80:83], a[196:199], v[20:35]
buffer_load_dwordx4 v217, s[52:55], s3 offen lds
v_add_u32 v214, s0, v237
v_lshl_add_u32 v223, v239, 4, v245
v_mfma_f32_32x32x16_bf16 v[36:51], a[84:87], a[192:195], v[36:51]
v_mov_b32 v210, 0x3f317218
v_xor_b32 v228, s77, v233
v_xor_b32 v229, s77, v235
v_or_b32 v228, v228, v229
v_cmp_ne_u32 vcc, 0, v228
s_cbranch_vccz L_svok_9
s_mov_b32 s98, 131072
v_lshlrev_b32 v230, 4, v246
v_add_u32 v230, 458752, v230
L_svpoll_10:
buffer_load_dwordx4 v[232:235], v230, s[60:63], 0 offen sc1
s_waitcnt vmcnt(0)
v_xor_b32 v228, s77, v233
v_xor_b32 v229, s77, v235
v_or_b32 v228, v228, v229
v_cmp_ne_u32 vcc, 0, v228
s_cbranch_vccz L_svok_9
s_sub_u32 s98, s98, 1
s_cbranch_scc0 L_svpoll_10
L_svok_9:
v_mfma_f32_32x32x16_bf16 v[52:67], a[84:87], a[196:199], v[52:67]
s_add_u32 s94, s94, 57344
s_cmp_eq_u32 s94, 401408
s_cselect_b32 s94, 0, s94
s_add_u32 m0, s91, 0x1000
s_add_u32 s3, s94, 0
buffer_load_dwordx4 v216, s[52:55], s3 offen lds
s_add_u32 m0, s91, 0x1400
v_permlane32_swap_b32 v164, v166
v_permlane32_swap_b32 v165, v167
v_permlane32_swap_b32 v168, v170
s_waitcnt vmcnt(16)
v_mfma_f32_32x32x16_bf16 v[4:19], a[88:91], a[200:203], v[4:19]
v_permlane32_swap_b32 v169, v171
v_mfma_f32_32x32x16_bf16 v[20:35], a[88:91], a[204:207], v[20:35]
buffer_load_dwordx4 v217, s[52:55], s3 offen lds
v_mul_f32 v226, v232, v234
v_lshlrev_b32 v92, 16, v164
v_mfma_f32_32x32x16_bf16 v[36:51], a[92:95], a[200:203], v[36:51]
v_and_b32 v93, 0xffff0000, v164
v_fma_f32 v108, v92, v234, -v226
v_fma_f32 v109, v93, v234, -v226
v_mfma_f32_32x32x16_bf16 v[52:67], a[92:95], a[204:207], v[52:67]
buffer_load_dwordx4 a[112:115], v237, s[60:63], s36 offen offset:2048 sc1
v_lshlrev_b32 v94, 16, v165
v_and_b32 v95, 0xffff0000, v165
v_fma_f32 v110, v94, v234, -v226
s_waitcnt vmcnt(16)
v_mfma_f32_32x32x16_bf16 v[4:19], a[96:99], a[208:211], v[4:19]
v_fma_f32 v111, v95, v234, -v226
v_mfma_f32_32x32x16_bf16 v[20:35], a[96:99], a[212:215], v[20:35]
buffer_load_dwordx4 a[116:119], v237, s[60:63], s37 offen offset:2048 sc1
v_lshlrev_b32 v96, 16, v166
v_and_b32 v97, 0xffff0000, v166
v_mfma_f32_32x32x16_bf16 v[36:51], a[100:103], a[208:211], v[36:51]
v_fma_f32 v112, v96, v234, -v226
v_fma_f32 v113, v97, v234, -v226
v_lshlrev_b32 v98, 16, v167
v_mfma_f32_32x32x16_bf16 v[52:67], a[100:103], a[212:215], v[52:67]
buffer_load_dwordx4 a[120:123], v237, s[60:63], s36 offen offset:3072 sc1
v_and_b32 v99, 0xffff0000, v167
v_fma_f32 v114, v98, v234, -v226
v_fma_f32 v115, v99, v234, -v226
s_waitcnt vmcnt(16)
v_mfma_f32_32x32x16_bf16 v[4:19], a[104:107], a[216:219], v[4:19]
ds_read_b64_tr_b16 v[68:69], v204 offset:6144
ds_read_b64_tr_b16 v[70:71], v204 offset:7168
v_lshlrev_b32 v100, 16, v168
v_mfma_f32_32x32x16_bf16 v[20:35], a[104:107], a[220:223], v[20:35]
ds_read_b64_tr_b16 v[72:73], v205 offset:6144
ds_read_b64_tr_b16 v[74:75], v205 offset:7168
buffer_load_dwordx4 a[124:127], v237, s[60:63], s37 offen offset:3072 sc1
v_and_b32 v101, 0xffff0000, v168
v_fma_f32 v116, v100, v234, -v226
v_mfma_f32_32x32x16_bf16 v[36:51], a[108:111], a[216:219], v[36:51]
v_fma_f32 v117, v101, v234, -v226
v_lshlrev_b32 v102, 16, v169
v_and_b32 v103, 0xffff0000, v169
v_mfma_f32_32x32x16_bf16 v[52:67], a[108:111], a[220:223], v[52:67]
s_add_u32 s93, s93, 4096
s_cmp_eq_u32 s93, 28672
s_cselect_b32 s93, 0, s93
s_add_u32 s36, s40, s93
s_add_u32 s37, s41, s93
buffer_load_dwordx4 a[128:131], v237, s[60:63], s36 offen offset:0 sc1
v_fma_f32 v118, v102, v234, -v226
v_fma_f32 v119, v103, v234, -v226
v_lshlrev_b32 v104, 16, v170
s_waitcnt lgkmcnt(0)
s_waitcnt vmcnt(16)
v_mfma_f32_32x32x16_bf16 v[4:19], v[68:71], a[224:227], v[4:19]
ds_read_b64_tr_b16 v[76:77], v204 offset:8192
ds_read_b64_tr_b16 v[78:79], v204 offset:9216
v_and_b32 v105, 0xffff0000, v170
v_mfma_f32_32x32x16_bf16 v[20:35], v[68:71], a[228:231], v[20:35]
ds_read_b64_tr_b16 v[80:81], v205 offset:8192
ds_read_b64_tr_b16 v[82:83], v205 offset:9216
s_add_u32 m0, s91, 0x1800
s_add_u32 s3, s94, 14336
buffer_load_dwordx4 v216, s[52:55], s3 offen lds
s_add_u32 m0, s91, 0x1c00
v_fma_f32 v120, v104, v234, -v226
v_fma_f32 v121, v105, v234, -v226
v_mfma_f32_32x32x16_bf16 v[36:51], v[72:75], a[224:227], v[36:51]
buffer_load_dwordx4 v217, s[52:55], s3 offen lds
v_lshlrev_b32 v106, 16, v171
v_and_b32 v107, 0xffff0000, v171
v_fma_f32 v122, v106, v234, -v226
v_mfma_f32_32x32x16_bf16 v[52:67], v[72:75], a[228:231], v[52:67]
buffer_load_dwordx4 a[132:135], v237, s[60:63], s37 offen offset:0 sc1
v_fma_f32 v123, v107, v234, -v226
s_waitcnt lgkmcnt(0)
s_waitcnt vmcnt(17)
v_mfma_f32_32x32x16_bf16 v[4:19], v[76:79], a[232:235], v[4:19]
ds_read_b64_tr_b16 v[68:69], v204 offset:10240
ds_read_b64_tr_b16 v[70:71], v204 offset:11264
v_mfma_f32_32x32x16_bf16 v[20:35], v[76:79], a[236:239], v[20:35]
ds_read_b64_tr_b16 v[72:73], v205 offset:10240
ds_read_b64_tr_b16 v[74:75], v205 offset:11264
s_add_u32 m0, s91, 0x2000
s_add_u32 s3, s94, 28672
buffer_load_dwordx4 v216, s[52:55], s3 offen lds
s_add_u32 m0, s91, 0x2400
v_mfma_f32_32x32x16_bf16 v[36:51], v[80:83], a[232:235], v[36:51]
buffer_load_dwordx4 v217, s[52:55], s3 offen lds
v_mfma_f32_32x32x16_bf16 v[52:67], v[80:83], a[236:239], v[52:67]
buffer_load_dwordx4 a[136:139], v237, s[60:63], s36 offen offset:1024 sc1
s_waitcnt lgkmcnt(0)
s_waitcnt vmcnt(18)
v_mfma_f32_32x32x16_bf16 v[4:19], v[68:71], a[240:243], v[4:19]
ds_read_b64_tr_b16 v[76:77], v204 offset:12288
ds_read_b64_tr_b16 v[78:79], v204 offset:13312
v_mfma_f32_32x32x16_bf16 v[20:35], v[68:71], a[244:247], v[20:35]
ds_read_b64_tr_b16 v[80:81], v205 offset:12288
ds_read_b64_tr_b16 v[82:83], v205 offset:13312
s_add_u32 m0, s91, 0x2800
s_add_u32 s3, s94, 43008
buffer_load_dwordx4 v216, s[52:55], s3 offen lds
s_add_u32 m0, s91, 0x2c00
v_mfma_f32_32x32x16_bf16 v[36:51], v[72:75], a[240:243], v[36:51]
buffer_load_dwordx4 v217, s[52:55], s3 offen lds
v_mfma_f32_32x32x16_bf16 v[52:67], v[72:75], a[244:247], v[52:67]
buffer_load_dwordx4 a[140:143], v237, s[60:63], s37 offen offset:1024 sc1
buffer_load_dword v197, v198, s[60:63], 0 offen sc1
s_waitcnt lgkmcnt(0)
s_waitcnt vmcnt(19)
v_mfma_f32_32x32x16_bf16 v[4:19], v[76:79], a[248:251], v[4:19]
ds_read_b64_tr_b16 v[68:69], v204 offset:14336
ds_read_b64_tr_b16 v[70:71], v204 offset:15360
v_mfma_f32_32x32x16_bf16 v[20:35], v[76:79], a[252:255], v[20:35]
ds_read_b64_tr_b16 v[72:73], v205 offset:14336
ds_read_b64_tr_b16 v[74:75], v205 offset:15360
buffer_load_dwordx4 a[144:147], v237, s[60:63], s36 offen offset:2048 sc1
v_mfma_f32_32x32x16_bf16 v[36:51], v[80:83], a[248:251], v[36:51]
buffer_load_dwordx4 a[148:151], v237, s[60:63], s37 offen offset:2048 sc1
v_mfma_f32_32x32x16_bf16 v[52:67], v[80:83], a[252:255], v[52:67]
buffer_load_dwordx4 a[152:155], v237, s[60:63], s36 offen offset:3072 sc1
s_waitcnt lgkmcnt(0)
s_waitcnt vmcnt(16)
v_mfma_f32_32x32x16_bf16 v[4:19], v[68:71], a[112:115], v[4:19]
ds_read_b64_tr_b16 v[76:77], v204 offset:16384
ds_read_b64_tr_b16 v[78:79], v204 offset:17408
v_mfma_f32_32x32x16_bf16 v[20:35], v[68:71], a[116:119], v[20:35]
ds_read_b64_tr_b16 v[80:81], v205 offset:16384
ds_read_b64_tr_b16 v[82:83], v205 offset:17408
buffer_load_dwordx4 a[156:159], v237, s[60:63], s37 offen offset:3072 sc1
v_mfma_f32_32x32x16_bf16 v[36:51], v[72:75], a[112:115], v[36:51]
s_add_u32 s93, s93, 4096
s_cmp_eq_u32 s93, 28672
s_cselect_b32 s93, 0, s93
s_add_u32 s36, s40, s93
s_add_u32 s37, s41, s93
buffer_load_dwordx4 a[160:163], v237, s[60:63], s36 offen offset:0 sc1
v_mfma_f32_32x32x16_bf16 v[52:67], v[72:75], a[116:119], v[52:67]
buffer_load_dwordx4 a[164:167], v237, s[60:63], s37 offen offset:0 sc1
s_waitcnt lgkmcnt(0)
s_waitcnt vmcnt(17)
v_mfma_f32_32x32x16_bf16 v[4:19], v[76:79], a[120:123], v[4:19]
ds_read_b64_tr_b16 v[68:69], v204 offset:18432
ds_read_b64_tr_b16 v[70:71], v204 offset:19456
v_mfma_f32_32x32x16_bf16 v[20:35], v[76:79], a[124:127], v[20:35]
ds_read_b64_tr_b16 v[72:73], v205 offset:18432
ds_read_b64_tr_b16 v[74:75], v205 offset:19456
buffer_load_dwordx4 a[168:171], v237, s[60:63], s36 offen offset:1024 sc1
v_mfma_f32_32x32x16_bf16 v[36:51], v[80:83], a[120:123], v[36:51]
buffer_load_dwordx4 a[172:175], v237, s[60:63], s37 offen offset:1024 sc1
v_mfma_f32_32x32x16_bf16 v[52:67], v[80:83], a[124:127], v[52:67]
buffer_load_dwordx4 a[176:179], v237, s[60:63], s36 offen offset:2048 sc1
s_waitcnt lgkmcnt(0)
s_waitcnt vmcnt(16)
v_mfma_f32_32x32x16_bf16 v[4:19], v[68:71], a[128:131], v[4:19]
ds_read_b64_tr_b16 v[76:77], v204 offset:20480
ds_read_b64_tr_b16 v[78:79], v204 offset:21504
v_mfma_f32_32x32x16_bf16 v[20:35], v[68:71], a[132:135], v[20:35]
ds_read_b64_tr_b16 v[80:81], v205 offset:20480
ds_read_b64_tr_b16 v[82:83], v205 offset:21504
buffer_load_dwordx4 a[180:183], v237, s[60:63], s37 offen offset:2048 sc1
v_mfma_f32_32x32x16_bf16 v[36:51], v[72:75], a[128:131], v[36:51]
buffer_load_dwordx4 a[184:187], v237, s[60:63], s36 offen offset:3072 sc1
v_mfma_f32_32x32x16_bf16 v[52:67], v[72:75], a[132:135], v[52:67]
buffer_load_dwordx4 a[188:191], v237, s[60:63], s37 offen offset:3072 sc1
s_waitcnt lgkmcnt(0)
s_waitcnt vmcnt(13)
v_mfma_f32_32x32x16_bf16 v[4:19], v[76:79], a[136:139], v[4:19]
ds_read_b64_tr_b16 v[68:69], v204 offset:0
ds_read_b64_tr_b16 v[70:71], v204 offset:1024
v_mfma_f32_32x32x16_bf16 v[20:35], v[76:79], a[140:143], v[20:35]
ds_read_b64_tr_b16 v[72:73], v205 offset:0
ds_read_b64_tr_b16 v[74:75], v205 offset:1024
v_mfma_f32_32x32x16_bf16 v[36:51], v[80:83], a[136:139], v[36:51]
v_mfma_f32_32x32x16_bf16 v[52:67], v[80:83], a[140:143], v[52:67]
s_waitcnt vmcnt(12)
v_cmp_ne_u32 vcc, s77, v197
s_cbranch_vccz L_flagok_11
s_mov_b32 s98, 131072
L_flagpoll_12:
buffer_load_dword v197, v198, s[60:63], 0 offen sc1
s_waitcnt vmcnt(0)
v_cmp_ne_u32 vcc, s77, v197
s_cbranch_vccz L_flagok_11
s_sub_u32 s98, s98, 1
s_cbranch_scc0 L_flagpoll_12
L_flagok_11:
s_waitcnt lgkmcnt(0)
s_waitcnt vmcnt(10)
v_mfma_f32_32x32x16_bf16 v[4:19], v[68:71], a[144:147], v[4:19]
ds_read_b64_tr_b16 v[76:77], v204 offset:2048
ds_read_b64_tr_b16 v[78:79], v204 offset:3072
v_mfma_f32_32x32x16_bf16 v[20:35], v[68:71], a[148:151], v[20:35]
ds_read_b64_tr_b16 v[80:81], v205 offset:2048
ds_read_b64_tr_b16 v[82:83], v205 offset:3072
buffer_load_dwordx4 v[84:87], v242, s[60:63], 0 offen sc1
v_mfma_f32_32x32x16_bf16 v[36:51], v[72:75], a[144:147], v[36:51]
buffer_load_dwordx4 v[88:91], v243, s[60:63], 0 offen sc1
v_mfma_f32_32x32x16_bf16 v[52:67], v[72:75], a[148:151], v[52:67]
s_waitcnt lgkmcnt(0)
s_waitcnt vmcnt(10)
v_mfma_f32_32x32x16_bf16 v[4:19], v[76:79], a[152:155], v[4:19]
ds_read_b64_tr_b16 v[68:69], v204 offset:4096
ds_read_b64_tr_b16 v[70:71], v204 offset:5120
v_mfma_f32_32x32x16_bf16 v[20:35], v[76:79], a[156:159], v[20:35]
ds_read_b64_tr_b16 v[72:73], v205 offset:4096
ds_read_b64_tr_b16 v[74:75], v205 offset:5120
v_mfma_f32_32x32x16_bf16 v[36:51], v[80:83], a[152:155], v[36:51]
v_mfma_f32_32x32x16_bf16 v[52:67], v[80:83], a[156:159], v[52:67]
s_waitcnt lgkmcnt(0)
s_waitcnt vmcnt(8)
v_mfma_f32_32x32x16_bf16 v[4:19], v[68:71], a[160:163], v[4:19]
ds_read_b64_tr_b16 v[76:77], v204 offset:6144
ds_read_b64_tr_b16 v[78:79], v204 offset:7168
v_mfma_f32_32x32x16_bf16 v[20:35], v[68:71], a[164:167], v[20:35]
ds_read_b64_tr_b16 v[80:81], v205 offset:6144
ds_read_b64_tr_b16 v[82:83], v205 offset:7168
v_mfma_f32_32x32x16_bf16 v[36:51], v[72:75], a[160:163], v[36:51]
v_mfma_f32_32x32x16_bf16 v[52:67], v[72:75], a[164:167], v[52:67]
s_waitcnt lgkmcnt(0)
s_waitcnt vmcnt(6)
v_mfma_f32_32x32x16_bf16 v[4:19], v[76:79], a[168:171], v[4:19]
ds_read_b64_tr_b16 v[68:69], v204 offset:8192
ds_read_b64_tr_b16 v[70:71], v204 offset:9216
v_mfma_f32_32x32x16_bf16 v[20:35], v[76:79], a[172:175], v[20:35]
ds_read_b64_tr_b16 v[72:73], v205 offset:8192
ds_read_b64_tr_b16 v[74:75], v205 offset:9216
v_mfma_f32_32x32x16_bf16 v[36:51], v[80:83], a[168:171], v[36:51]
v_mfma_f32_32x32x16_bf16 v[52:67], v[80:83], a[172:175], v[52:67]
s_waitcnt lgkmcnt(0)
s_waitcnt vmcnt(4)
v_mfma_f32_32x32x16_bf16 v[4:19], v[68:71], a[176:179], v[4:19]
ds_read_b64_tr_b16 v[76:77], v204 offset:10240
ds_read_b64_tr_b16 v[78:79], v204 offset:11264
v_mfma_f32_32x32x16_bf16 v[20:35], v[68:71], a[180:183], v[20:35]
ds_read_b64_tr_b16 v[80:81], v205 offset:10240
ds_read_b64_tr_b16 v[82:83], v205 offset:11264
v_mfma_f32_32x32x16_bf16 v[36:51], v[72:75], a[176:179], v[36:51]
v_mfma_f32_32x32x16_bf16 v[52:67], v[72:75], a[180:183], v[52:67]
s_waitcnt lgkmcnt(0)
s_waitcnt vmcnt(2)
v_mfma_f32_32x32x16_bf16 v[4:19], v[76:79], a[184:187], v[4:19]
v_mfma_f32_32x32x16_bf16 v[20:35], v[76:79], a[188:191], v[20:35]
v_mfma_f32_32x32x16_bf16 v[36:51], v[80:83], a[184:187], v[36:51]
v_mfma_f32_32x32x16_bf16 v[52:67], v[80:83], a[188:191], v[52:67]
s_nop 9
ds_write_b128 v224, v[20:23] offset:0
ds_write_b128 v224, v[24:27] offset:1024
ds_write_b128 v224, v[28:31] offset:2048
ds_write_b128 v224, v[32:35] offset:3072
ds_write_b128 v224, v[36:39] offset:4096
ds_write_b128 v224, v[40:43] offset:5120
ds_write_b128 v224, v[44:47] offset:6144
ds_write_b128 v224, v[48:51] offset:7168
ds_write_b128 v224, v[52:55] offset:8192
ds_write_b128 v224, v[56:59] offset:9216
ds_write_b128 v224, v[60:63] offset:10240
ds_write_b128 v224, v[64:67] offset:11264
s_waitcnt vmcnt(0)
ds_write_b128 v236, v[84:87]
ds_write_b128 v236, v[88:91] offset:1024
s_waitcnt lgkmcnt(0)
s_barrier
ds_read_b64_tr_b16 v[84:85], v225 offset:0
ds_read_b64_tr_b16 v[86:87], v225 offset:1024
ds_read_b64_tr_b16 v[88:89], v225 offset:2048
ds_read_b64_tr_b16 v[90:91], v225 offset:3072
ds_read_b128 v[68:71], v212 offset:0
ds_read_b128 v[72:75], v212 offset:1024
ds_read_b128 v[76:79], v212 offset:2048
ds_read_b128 v[80:83], v212 offset:3072
ds_read_b128 v[124:127], v213 offset:4096
ds_read_b128 v[128:131], v213 offset:5120
ds_read_b128 v[132:135], v213 offset:6144
ds_read_b128 v[136:139], v213 offset:7168
ds_read_b128 v[140:143], v214 offset:8192
ds_read_b128 v[144:147], v214 offset:9216
ds_read_b128 v[148:151], v214 offset:10240
ds_read_b128 v[152:155], v214 offset:11264
s_waitcnt lgkmcnt(12)
v_lshlrev_b32 v228, 16, v84
v_and_b32 v229, 0xffff0000, v84
v_pk_fma_f32 v[92:93], v[108:109], v[228:229], v[92:93]
v_lshlrev_b32 v230, 16, v85
v_and_b32 v231, 0xffff0000, v85
v_pk_fma_f32 v[94:95], v[110:111], v[230:231], v[94:95]
v_lshlrev_b32 v228, 16, v86
v_and_b32 v229, 0xffff0000, v86
v_pk_fma_f32 v[96:97], v[112:113], v[228:229], v[96:97]
v_lshlrev_b32 v230, 16, v87
v_and_b32 v231, 0xffff0000, v87
v_pk_fma_f32 v[98:99], v[114:115], v[230:231], v[98:99]
v_lshlrev_b32 v228, 16, v88
v_and_b32 v229, 0xffff0000, v88
v_pk_fma_f32 v[100:101], v[116:117], v[228:229], v[100:101]
v_lshlrev_b32 v230, 16, v89
v_and_b32 v231, 0xffff0000, v89
v_pk_fma_f32 v[102:103], v[118:119], v[230:231], v[102:103]
v_lshlrev_b32 v228, 16, v90
v_and_b32 v229, 0xffff0000, v90
v_pk_fma_f32 v[104:105], v[120:121], v[228:229], v[104:105]
v_lshlrev_b32 v230, 16, v91
v_and_b32 v231, 0xffff0000, v91
v_pk_fma_f32 v[106:107], v[122:123], v[230:231], v[106:107]
s_waitcnt lgkmcnt(8)
v_pk_add_f32 v[4:5], v[4:5], v[68:69]
v_pk_add_f32 v[6:7], v[6:7], v[70:71]
v_pk_add_f32 v[8:9], v[8:9], v[72:73]
v_pk_add_f32 v[10:11], v[10:11], v[74:75]
v_pk_add_f32 v[12:13], v[12:13], v[76:77]
v_pk_add_f32 v[14:15], v[14:15], v[78:79]
v_pk_add_f32 v[16:17], v[16:17], v[80:81]
v_pk_add_f32 v[18:19], v[18:19], v[82:83]
s_waitcnt lgkmcnt(4)
v_pk_add_f32 v[4:5], v[4:5], v[124:125]
v_pk_add_f32 v[6:7], v[6:7], v[126:127]
v_pk_add_f32 v[8:9], v[8:9], v[128:129]
v_pk_add_f32 v[10:11], v[10:11], v[130:131]
v_pk_add_f32 v[12:13], v[12:13], v[132:133]
v_pk_add_f32 v[14:15], v[14:15], v[134:135]
v_pk_add_f32 v[16:17], v[16:17], v[136:137]
v_pk_add_f32 v[18:19], v[18:19], v[138:139]
s_waitcnt lgkmcnt(0)
v_pk_add_f32 v[4:5], v[4:5], v[140:141]
v_pk_add_f32 v[6:7], v[6:7], v[142:143]
v_pk_add_f32 v[8:9], v[8:9], v[144:145]
v_pk_add_f32 v[10:11], v[10:11], v[146:147]
v_pk_add_f32 v[12:13], v[12:13], v[148:149]
v_pk_add_f32 v[14:15], v[14:15], v[150:151]
v_pk_add_f32 v[16:17], v[16:17], v[152:153]
v_pk_add_f32 v[18:19], v[18:19], v[154:155]
v_pk_fma_f32 v[92:93], v[4:5], v[210:211], v[92:93] op_sel_hi:[1,0,1]
v_pk_fma_f32 v[94:95], v[6:7], v[210:211], v[94:95] op_sel_hi:[1,0,1]
v_pk_fma_f32 v[96:97], v[8:9], v[210:211], v[96:97] op_sel_hi:[1,0,1]
v_pk_fma_f32 v[98:99], v[10:11], v[210:211], v[98:99] op_sel_hi:[1,0,1]
v_cvt_pk_bf16_f32 v156, v92, v93
v_cvt_pk_bf16_f32 v157, v94, v95
v_cvt_pk_bf16_f32 v158, v96, v97
v_cvt_pk_bf16_f32 v159, v98, v99
s_nop 0
v_permlane32_swap_b32 v156, v158
v_permlane32_swap_b32 v157, v159
buffer_store_dwordx4 v[156:159], v223, s[56:59], 0 offen offset:0
v_pk_fma_f32 v[100:101], v[12:13], v[210:211], v[100:101] op_sel_hi:[1,0,1]
v_pk_fma_f32 v[102:103], v[14:15], v[210:211], v[102:103] op_sel_hi:[1,0,1]
v_pk_fma_f32 v[104:105], v[16:17], v[210:211], v[104:105] op_sel_hi:[1,0,1]
v_pk_fma_f32 v[106:107], v[18:19], v[210:211], v[106:107] op_sel_hi:[1,0,1]
v_cvt_pk_bf16_f32 v160, v100, v101
v_cvt_pk_bf16_f32 v161, v102, v103
v_cvt_pk_bf16_f32 v162, v104, v105
v_cvt_pk_bf16_f32 v163, v106, v107
s_nop 0
v_permlane32_swap_b32 v160, v162
v_permlane32_swap_b32 v161, v163
buffer_store_dwordx4 v[160:163], v223, s[56:59], 0 offen offset:32
s_endpgm
L_help:
s_waitcnt lgkmcnt(0)
s_mov_b32 s60, s28
s_mov_b32 s61, s29
s_mov_b32 s62, 0xb01000
s_mov_b32 s63, 0x00020000
v_mov_b32 v28, 0
buffer_load_dword v29, v28, s[60:63], 0 offen sc1
s_getpc_b64 s[30:31]
L_pc:
s_sub_u32 s30, s30, L_pc-L_code_begin
s_subb_u32 s31, s31, 0
v_lshlrev_b32 v8, 7, v0
v_min_u32 v8, L_code_end-L_code_begin-4, v8
v_mov_b32 v9, s31
v_add_co_u32 v8, vcc, s30, v8
s_nop 1
v_addc_co_u32 v9, vcc, 0, v9, vcc
global_load_dword v10, v[8:9], off
s_mov_b32 s52, s22
s_mov_b32 s53, s23
s_mov_b32 s54, 0x188000
s_mov_b32 s55, 0x00020000
s_and_b32 s78, s2, 7
s_lshr_b32 s79, s2, 3
s_lshl_b32 s79, s79, 2
s_add_u32 s79, s79, s73
v_mul_u32_u24 v12, 896, v1
s_add_u32 s84, s79, 0
s_min_u32 s84, s84, 27
s_lshr_b32 s85, s84, 2
s_and_b32 s86, s84, 3
s_add_u32 s87, s85, s78
s_cmp_ge_u32 s87, 7
s_cselect_b32 s80, 7, 0
s_sub_u32 s87, s87, s80
s_cmp_ge_u32 s87, 7
s_cselect_b32 s80, 7, 0
s_sub_u32 s87, s87, s80
s_mul_i32 s87, s87, 57344
s_mul_i32 s86, s86, 401408
s_lshl_b32 s85, s85, 7
s_add_u32 s86, s86, s85
s_add_u32 s88, s79, 16
s_min_u32 s88, s88, 27
s_lshr_b32 s89, s88, 2
s_and_b32 s90, s88, 3
s_add_u32 s91, s89, s78
s_cmp_ge_u32 s91, 7
s_cselect_b32 s80, 7, 0
s_sub_u32 s91, s91, s80
s_cmp_ge_u32 s91, 7
s_cselect_b32 s80, 7, 0
s_sub_u32 s91, s91, s80
s_mul_i32 s91, s91, 57344
s_mul_i32 s90, s90, 401408
s_lshl_b32 s89, s89, 7
s_add_u32 s90, s90, s89
s_add_u32 s80, s86, s87
buffer_load_dword v13, v12, s[52:55], s80 offen
s_add_u32 s87, s87, 57344
s_cmp_eq_u32 s87, 401408
s_cselect_b32 s87, 0, s87
s_add_u32 s80, s90, s91
buffer_load_dword v14, v12, s[52:55], s80 offen
s_add_u32 s91, s91, 57344
s_cmp_eq_u32 s91, 401408
s_cselect_b32 s91, 0, s91
s_add_u32 s80, s86, s87
buffer_load_dword v13, v12, s[52:55], s80 offen
s_add_u32 s87, s87, 57344
s_cmp_eq_u32 s87, 401408
s_cselect_b32 s87, 0, s87
s_add_u32 s80, s90, s91
buffer_load_dword v14, v12, s[52:55], s80 offen
s_add_u32 s91, s91, 57344
s_cmp_eq_u32 s91, 401408
s_cselect_b32 s91, 0, s91
s_add_u32 s80, s86, s87
buffer_load_dword v13, v12, s[52:55], s80 offen
s_add_u32 s87, s87, 57344
s_cmp_eq_u32 s87, 401408
s_cselect_b32 s87, 0, s87
s_add_u32 s80, s90, s91
buffer_load_dword v14, v12, s[52:55], s80 offen
s_add_u32 s91, s91, 57344
s_cmp_eq_u32 s91, 401408
s_cselect_b32 s91, 0, s91
s_add_u32 s80, s86, s87
buffer_load_dword v13, v12, s[52:55], s80 offen
s_add_u32 s87, s87, 57344
s_cmp_eq_u32 s87, 401408
s_cselect_b32 s87, 0, s87
s_add_u32 s80, s90, s91
buffer_load_dword v14, v12, s[52:55], s80 offen
s_add_u32 s91, s91, 57344
s_cmp_eq_u32 s91, 401408
s_cselect_b32 s91, 0, s91
s_add_u32 s80, s86, s87
buffer_load_dword v13, v12, s[52:55], s80 offen
s_add_u32 s87, s87, 57344
s_cmp_eq_u32 s87, 401408
s_cselect_b32 s87, 0, s87
s_add_u32 s80, s90, s91
buffer_load_dword v14, v12, s[52:55], s80 offen
s_add_u32 s91, s91, 57344
s_cmp_eq_u32 s91, 401408
s_cselect_b32 s91, 0, s91
s_add_u32 s80, s86, s87
buffer_load_dword v13, v12, s[52:55], s80 offen
s_add_u32 s87, s87, 57344
s_cmp_eq_u32 s87, 401408
s_cselect_b32 s87, 0, s87
s_add_u32 s80, s90, s91
buffer_load_dword v14, v12, s[52:55], s80 offen
s_add_u32 s91, s91, 57344
s_cmp_eq_u32 s91, 401408
s_cselect_b32 s91, 0, s91
s_add_u32 s80, s86, s87
buffer_load_dword v13, v12, s[52:55], s80 offen
s_add_u32 s87, s87, 57344
s_cmp_eq_u32 s87, 401408
s_cselect_b32 s87, 0, s87
s_add_u32 s80, s90, s91
buffer_load_dword v14, v12, s[52:55], s80 offen
s_add_u32 s91, s91, 57344
s_cmp_eq_u32 s91, 401408
s_cselect_b32 s91, 0, s91
s_waitcnt vmcnt(0)
s_cmp_lg_u32 s2, 0
s_cbranch_scc1 L_end
s_cmp_lg_u32 s73, 0
s_cbranch_scc1 L_end
s_mov_b32 s78, 0x41c64e6d
v_mul_lo_u32 v29, v29, s78
v_add_u32 v29, 0x3039, v29
v_lshlrev_b32 v30, 4, v1
v_add_u32 v30, 8192, v30
v_add_u32 v31, 3072, v30
v_min_u32 v31, 11760, v31
s_mov_b32 s98, 131072
L_epoch:
buffer_load_dwordx4 v[8:11], v30, s[60:63], 0 offen offset:0 sc1
buffer_load_dwordx4 v[12:15], v30, s[60:63], 0 offen offset:1024 sc1
buffer_load_dwordx4 v[16:19], v30, s[60:63], 0 offen offset:2048 sc1
buffer_load_dwordx4 v[20:23], v31, s[60:63], 0 offen sc1
s_waitcnt vmcnt(0)
v_xor_b32 v24, v8, v29
v_xor_b32 v25, v9, v29
v_or_b32 v24, v24, v25
v_xor_b32 v25, v10, v29
v_or_b32 v24, v24, v25
v_xor_b32 v25, v11, v29
v_or_b32 v24, v24, v25
v_xor_b32 v25, v12, v29
v_or_b32 v24, v24, v25
v_xor_b32 v25, v13, v29
v_or_b32 v24, v24, v25
v_xor_b32 v25, v14, v29
v_or_b32 v24, v24, v25
v_xor_b32 v25, v15, v29
v_or_b32 v24, v24, v25
v_xor_b32 v25, v16, v29
v_or_b32 v24, v24, v25
v_xor_b32 v25, v17, v29
v_or_b32 v24, v24, v25
v_xor_b32 v25, v18, v29
v_or_b32 v24, v24, v25
v_xor_b32 v25, v19, v29
v_or_b32 v24, v24, v25
v_xor_b32 v25, v20, v29
v_or_b32 v24, v24, v25
v_xor_b32 v25, v21, v29
v_or_b32 v24, v24, v25
v_xor_b32 v25, v22, v29
v_or_b32 v24, v24, v25
v_xor_b32 v25, v23, v29
v_or_b32 v24, v24, v25
v_cmp_ne_u32 vcc, 0, v24
s_cbranch_vccz L_epoch_ok
s_sub_u32 s98, s98, 1
s_cbranch_scc0 L_epoch
L_epoch_ok:
s_mov_b64 exec, 1
buffer_store_dword v29, v28, s[60:63], 0 offen sc1
s_waitcnt vmcnt(0)
L_end:
s_endpgm
L_code_end:
.section .rodata,"a"
.p2align 6
.amdhsa_kernel parallel_sum__ssm_conv_h3__dense_activation_mish__prompt_kernel
  .amdhsa_next_free_vgpr 512
  .amdhsa_next_free_sgpr 102
  .amdhsa_accum_offset 256
  .amdhsa_group_segment_fixed_size 0
  .amdhsa_kernarg_size 104
  .amdhsa_user_sgpr_count 2
  .amdhsa_user_sgpr_kernarg_segment_ptr 1
  .amdhsa_system_sgpr_workgroup_id_x 1
  .amdhsa_float_denorm_mode_32 3
.end_amdhsa_kernel
```
